```python
import torch

def _softmax(x, axis=-1):
    return torch.softmax(x, dim=axis)
def _gelu(x):
    return torch.nn.functional.gelu(x, approximate="tanh")
def _silu(x):
    return torch.nn.functional.silu(x)
def _sigmoid(x):
    return torch.sigmoid(x)
def _layernorm(x, axis=-1, eps=1e-5):
    m = x.mean(dim=axis, keepdim=True)
    v = x.var(dim=axis, keepdim=True, unbiased=False)
    return (x - m) / torch.sqrt(v + eps)
def _scatter_add(tgt, idx, src, axis=0):
    return tgt.clone().index_add_(axis, idx, src)
def _segment_sum(src, seg, n):
    out = torch.zeros((n,) + src.shape[1:], dtype=src.dtype)
    return out.index_add_(0, seg, src)
def _pad(x, pw):
    flat = tuple(v for pair in reversed(pw) for v in pair)
    return torch.nn.functional.pad(x, flat)

kernel_name = 'concat_heads__gqa_block_cached__sliding_block_cached__decode'

def setup_inputs():

    _w = (lambda a: (lambda t: t.to(torch.bfloat16) if t.is_floating_point() else t)(torch.as_tensor(a)))
    def _A_setup():
        B, Sq, D = 2, 1, 1024
        Hq, Hkv, Sk, Dh = 32, 4, 32768, 128
        assert Hq % Hkv == 0, (Hq, Hkv)
        return {
            "x": _w((lambda *s: torch.randn(*s, dtype=torch.bfloat16) * 0.8)(B, Sq, D)),
            "k_cache": _w((lambda *s: torch.randn(*s, dtype=torch.bfloat16) * 1.6)(B, Hkv, Sk, Dh)),
            "v_cache": _w((lambda *s: torch.randn(*s, dtype=torch.bfloat16) * 0.2)(B, Hkv, Sk, Dh)),
            "wq": _w((lambda *s: torch.randn(*s, dtype=torch.bfloat16) * 1.6)(D, Hq * Dh) * (D ** -0.5)),
            "wo": _w((lambda *s: torch.randn(*s, dtype=torch.bfloat16) * 0.2)(Hq * Dh, D) * ((Hq * Dh) ** -0.5)),
        }
    _A_in = _A_setup()

    def _B_setup():
        B, Sq, D = 2, 1, 1024
        Hq, Hkv, Sk, Dh = 32, 4, 32768, 128
        assert Hq % Hkv == 0, (Hq, Hkv)
        return {
            "x": _w((lambda *s: torch.randn(*s, dtype=torch.bfloat16) * 0.8)(B, Sq, D)),
            "k_cache": _w((lambda *s: torch.randn(*s, dtype=torch.bfloat16) * 1.6)(B, Hkv, Sk, Dh)),
            "v_cache": _w((lambda *s: torch.randn(*s, dtype=torch.bfloat16) * 0.2)(B, Hkv, Sk, Dh)),
            "wq": _w((lambda *s: torch.randn(*s, dtype=torch.bfloat16) * 1.6)(D, Hq * Dh) * (D ** -0.5)),
            "wo": _w((lambda *s: torch.randn(*s, dtype=torch.bfloat16) * 0.2)(Hq * Dh, D) * ((Hq * Dh) ** -0.5)),
        }
    _B_in = _B_setup()

    return {
        "A_x": _A_in["x"],
        "A_k_cache": _A_in["k_cache"],
        "A_v_cache": _A_in["v_cache"],
        "A_wq": _A_in["wq"],
        "A_wo": _A_in["wo"],
        "B_x": _B_in["x"],
        "B_k_cache": _B_in["k_cache"],
        "B_v_cache": _B_in["v_cache"],
        "B_wq": _B_in["wq"],
        "B_wo": _B_in["wo"],
    }

def reference(A_x, A_k_cache, A_v_cache, A_wq, A_wo, B_x, B_k_cache, B_v_cache, B_wq, B_wo):
    def _A_ref(x, k_cache, v_cache, wq, wo):
        B, Sq, D = x.shape
        Hq, Dh = 32, 128
        Hkv = k_cache.shape[1]
        rep = Hq // Hkv
        q = (lambda x, *d: x.permute(*d))((x @ wq).reshape(B, Sq, Hq, Dh), 0, 2, 1, 3)
        k = (lambda x, n, axis: torch.repeat_interleave(x, n, dim=axis))(k_cache, rep, axis=1)
        v = (lambda x, n, axis: torch.repeat_interleave(x, n, dim=axis))(v_cache, rep, axis=1)
        scores = torch.einsum("bhqd,bhkd->bhqk", q, k) * (Dh ** -0.5)
        p = _softmax(scores, axis=-1)
        o = torch.einsum("bhqk,bhkd->bhqd", p, v)
        return (lambda x, *d: x.permute(*d))(o, 0, 2, 1, 3).reshape(B, Sq, Hq * Dh) @ wo

    def _B_ref(x, k_cache, v_cache, wq, wo):
        B, Sq, D = x.shape
        Hq, Dh = 32, 128
        Hkv, Sk = k_cache.shape[1], k_cache.shape[2]
        W = min(4096, max(256, Sk // 4))
        rep = Hq // Hkv
        q = (lambda x, *d: x.permute(*d))((x @ wq).reshape(B, Sq, Hq, Dh), 0, 2, 1, 3)
        k = (lambda x, n, axis: torch.repeat_interleave(x, n, dim=axis))(k_cache[:, :, Sk - W:, :], rep, axis=1)
        v = (lambda x, n, axis: torch.repeat_interleave(x, n, dim=axis))(v_cache[:, :, Sk - W:, :], rep, axis=1)
        scores = torch.einsum("bhqd,bhkd->bhqk", q, k) * (Dh ** -0.5)
        p = _softmax(scores, axis=-1)
        o = torch.einsum("bhqk,bhkd->bhqd", p, v)
        return (lambda x, *d: x.permute(*d))(o, 0, 2, 1, 3).reshape(B, Sq, Hq * Dh) @ wo

    a = _A_ref(A_x, A_k_cache, A_v_cache, A_wq, A_wo)
    b = _B_ref(B_x, B_k_cache, B_v_cache, B_wq, B_wo)
    return torch.concatenate([a, b], axis=-1)
```

```asm
; @launch grid=(256,1,1) block=(512,1,1) lds=77824
.amdgcn_target "amdgcn-amd-amdhsa--gfx950"
.text
.globl concat_heads__gqa_block_cached__sliding_block_cached__decode_kernel
.p2align 8
.type concat_heads__gqa_block_cached__sliding_block_cached__decode_kernel,@function
concat_heads__gqa_block_cached__sliding_block_cached__decode_kernel:
    s_cmp_ge_u32 s2, 256
    s_cbranch_scc1 L_end
    s_load_dwordx16 s[64:79], s[0:1], 0
    s_load_dwordx8 s[80:87], s[0:1], 64
    s_load_dwordx2 s[88:89], s[0:1], 96
    v_lshrrev_b32 v1, 6, v0
    v_and_b32 v0, 63, v0
    v_readfirstlane_b32 s40, v1
    s_and_b32 s41, s2, 1
    s_bfe_u32 s42, s2, 0x20001
    s_lshr_b32 s43, s2, 3
    v_lshrrev_b32 v9, 3, v0
    v_and_b32 v10, 7, v0
    v_lshlrev_b32 v10, 4, v10
    v_lshl_or_b32 v3, v9, 16, v10
    v_lshrrev_b32 v12, 4, v0
    v_bfe_u32 v9, v0, 2, 1
    v_and_b32 v10, 1, v0
    v_lshl_or_b32 v10, v12, 1, v10
    v_lshlrev_b32 v10, 4, v10
    v_lshl_or_b32 v11, v9, 11, v10
    s_and_b32 s58, s43, 1
    s_lshl_b32 s58, s58, 3
    s_add_u32 s58, s58, s40
    s_lshl_b32 s44, s58, 19
    s_lshl_b32 s57, s58, 7
    s_lshl_b32 s58, s42, 11
    s_lshr_b32 s59, s43, 1
    s_lshl_b32 s59, s59, 7
    s_add_u32 s44, s44, s58
    s_add_u32 s44, s44, s59
    s_mov_b32 s6, 4096
    s_mov_b32 s7, 0x20000
    s_mov_b32 s10, 0x800000
    s_mov_b32 s11, 0x20000
    v_mov_b32 v16, 0
    v_lshlrev_b32 v17, 2, v0
    s_mov_b64 vcc, 0
    s_cmp_eq_u32 s41, 0
    s_waitcnt lgkmcnt(0)
    s_cselect_b64 s[4:5], s[64:65], s[74:75]
    s_cselect_b64 s[8:9], s[70:71], s[80:81]
    s_cselect_b64 s[28:29], s[72:73], s[82:83]
    buffer_load_dwordx4 v[64:67], v3, s[8:11], s44 offen nt
    s_add_u32 s44, s44, 8192
    buffer_load_dwordx4 v[68:71], v3, s[8:11], s44 offen nt
    s_add_u32 s44, s44, 8192
    buffer_load_dwordx4 v[72:75], v3, s[8:11], s44 offen nt
    s_add_u32 s44, s44, 8192
    s_load_dword s46, s[88:89], 0
    ds_write_b32 v17, v16 offset:10752
    s_lshr_b32 s58, s8, 7
    s_lshr_b32 s59, s43, 1
    s_add_u32 s58, s58, s59
    s_and_b32 s58, s58, 7
    s_cmp_eq_u32 s58, 3
    s_cselect_b32 s99, 0, 4
    s_cmp_ge_u32 s43, 28
    s_cselect_b32 s97, 1, 0
    s_cselect_b32 s96, 32, 224
    s_cselect_b64 s[12:13], s[76:77], s[66:67]
    s_cselect_b64 s[16:17], s[78:79], s[68:69]
    s_cselect_b32 s99, 2, s99
    s_lshl_b32 s96, s96, 12
    s_lshl_b32 s95, s96, 3
    s_mov_b32 s14, 0x4000000
    s_mov_b32 s15, 0x20000
    s_mov_b32 s18, 0x4000000
    s_mov_b32 s19, 0x20000
    s_mov_b64 s[20:21], s[66:67]
    s_mov_b32 s22, 0x4000000
    s_mov_b32 s23, 0x20000
    s_mov_b64 s[24:25], s[68:69]
    s_mov_b32 s26, 0x4000000
    s_mov_b32 s27, 0x20000
    s_mov_b64 s[32:33], s[88:89]
    s_mov_b32 s34, 0x600000
    s_mov_b32 s35, 0x20000
    s_mov_b64 s[36:37], s[84:85]
    s_mov_b32 s38, 0x2000
    s_mov_b32 s39, 0x20000
    s_mov_b32 s30, 0x800000
    s_mov_b32 s31, 0x20000
    v_lshlrev_b32 v2, 4, v0
    v_bfe_u32 v9, v0, 1, 1
    v_lshlrev_b32 v1, 4, v12
    v_lshl_or_b32 v1, v9, 10, v1
    v_bfe_u32 v9, v0, 2, 2
    v_lshl_or_b32 v1, v9, 8, v1
    v_and_b32 v9, 1, v0
    v_lshl_or_b32 v1, v9, 6, v1
    s_lshl_b32 s101, s41, 2
    s_add_u32 s101, s101, s42
    s_lshl_b32 s58, s101, 23
    s_lshl_b32 s59, s43, 3
    s_add_u32 s59, s59, s40
    s_lshl_b32 s59, s59, 12
    s_add_u32 s45, s58, s59
    s_add_u32 s100, s45, 7340032
    s_lshl_b32 s59, s43, 18
    s_add_u32 s45, s58, s59
    s_lshl_b32 s59, s40, 12
    s_add_u32 s45, s45, s59
    s_mov_b32 s96, 32768
    s_mov_b32 s95, 262144
    s_mul_i32 s58, s97, 0
    s_add_u32 s45, s45, s58
    s_mov_b32 s48, 0x05040100
    s_mov_b32 s49, 0x07060302
    s_mov_b32 s50, 0x0c0c0400
    s_mov_b32 s51, 0x04000c0c
    s_mov_b32 s52, 0x3e0293ee
    s_mov_b32 s53, 0x7060500
    s_mov_b32 s54, 0x7060501
    s_mov_b32 s55, 0x7060502
    s_mov_b32 s56, 0x7060503
    s_waitcnt lgkmcnt(0)
    s_barrier
    s_waitcnt vmcnt(2)
    buffer_load_dwordx4 v[76:79], v3, s[8:11], s44 offen nt
    s_add_u32 s44, s44, 8192
    s_waitcnt vmcnt(2)
    buffer_load_dwordx4 v[80:83], v3, s[8:11], s44 offen nt
    s_add_u32 s44, s44, 8192
    s_waitcnt vmcnt(2)
    buffer_load_dwordx4 v[84:87], v3, s[8:11], s44 offen nt
    s_add_u32 s44, s44, 8192
    s_waitcnt vmcnt(2)
    buffer_load_dwordx4 v[88:91], v3, s[8:11], s44 offen nt
    s_add_u32 s44, s44, 8192
    s_waitcnt vmcnt(2)
    buffer_load_dwordx4 v[92:95], v3, s[8:11], s44 offen nt
    s_add_u32 s44, s44, 8192
    buffer_load_dwordx4 v[4:7], v11, s[4:7], s57 offen
    s_mul_i32 s46, s46, 0x9e3779b1
    s_add_u32 s46, s46, 0x7f4a7c15
    v_mov_b32 v8, s46
    s_waitcnt vmcnt(3)
    buffer_load_dwordx4 v[96:99], v1, s[20:23], s100 offen offset:0 nt
    s_waitcnt vmcnt(3)
    buffer_load_dwordx4 v[100:103], v1, s[20:23], s100 offen offset:128 nt
    s_waitcnt vmcnt(3)
    buffer_load_dwordx4 v[104:107], v1, s[20:23], s100 offen offset:2048 nt
    s_waitcnt vmcnt(3)
    v_perm_b32 v224, v68, v64, s48
    v_perm_b32 v225, v76, v72, s48
    v_perm_b32 v226, v84, v80, s48
    v_perm_b32 v227, v92, v88, s48
    v_perm_b32 v228, v68, v64, s49
    v_perm_b32 v229, v76, v72, s49
    v_perm_b32 v230, v84, v80, s49
    v_perm_b32 v231, v92, v88, s49
    v_mfma_f32_16x16x32_bf16 v[32:35], v[4:7], v[224:227], 0
    v_perm_b32 v232, v69, v65, s48
    v_perm_b32 v233, v77, v73, s48
    v_perm_b32 v234, v85, v81, s48
    v_perm_b32 v235, v93, v89, s48
    v_mfma_f32_16x16x32_bf16 v[36:39], v[4:7], v[228:231], 0
    v_perm_b32 v236, v69, v65, s49
    v_perm_b32 v237, v77, v73, s49
    v_perm_b32 v238, v85, v81, s49
    v_perm_b32 v239, v93, v89, s49
    v_mfma_f32_16x16x32_bf16 v[40:43], v[4:7], v[232:235], 0
    v_perm_b32 v224, v70, v66, s48
    v_perm_b32 v225, v78, v74, s48
    v_perm_b32 v226, v86, v82, s48
    v_perm_b32 v227, v94, v90, s48
    v_mfma_f32_16x16x32_bf16 v[44:47], v[4:7], v[236:239], 0
    v_perm_b32 v228, v70, v66, s49
    v_perm_b32 v229, v78, v74, s49
    v_perm_b32 v230, v86, v82, s49
    v_perm_b32 v231, v94, v90, s49
    v_mfma_f32_16x16x32_bf16 v[48:51], v[4:7], v[224:227], 0
    v_perm_b32 v232, v71, v67, s48
    v_perm_b32 v233, v79, v75, s48
    v_perm_b32 v234, v87, v83, s48
    v_perm_b32 v235, v95, v91, s48
    v_mfma_f32_16x16x32_bf16 v[52:55], v[4:7], v[228:231], 0
    v_perm_b32 v236, v71, v67, s49
    v_perm_b32 v237, v79, v75, s49
    v_perm_b32 v238, v87, v83, s49
    v_perm_b32 v239, v95, v91, s49
    v_mfma_f32_16x16x32_bf16 v[56:59], v[4:7], v[232:235], 0
    s_nop 1
    v_mfma_f32_16x16x32_bf16 v[60:63], v[4:7], v[236:239], 0
    v_mov_b32 v9, 0
    v_mov_b32 v10, 1
    s_mov_b32 exec_lo, 0x1
    s_mov_b32 exec_hi, 0x0
    ds_add_rtn_u32 v10, v9, v10 offset:10780
    s_waitcnt lgkmcnt(0)
    v_cmp_le_u32 vcc, s99, v10
    s_mov_b64 exec, -1
    s_cbranch_vccnz L_sk1
    s_waitcnt vmcnt(2)
L_sk1:
    buffer_load_dwordx4 v[108:111], v1, s[20:23], s100 offen offset:2176 nt
    v_and_b32 v9, 15, v0
    v_lshlrev_b32 v9, 5, v9
    v_lshl_or_b32 v9, v12, 8, v9
    s_lshl_b32 s58, s40, 9
    v_add_u32 v13, s58, v9
    v_add_f32_dpp v64, v33, v32 row_ror:8 row_mask:0xf bank_mask:0xf
    v_add_f32_dpp v65, v37, v36 row_ror:8 row_mask:0xf bank_mask:0xf
    v_add_f32_dpp v66, v41, v40 row_ror:8 row_mask:0xf bank_mask:0xf
    v_add_f32_dpp v67, v45, v44 row_ror:8 row_mask:0xf bank_mask:0xf
    v_add_f32_dpp v68, v49, v48 row_ror:8 row_mask:0xf bank_mask:0xf
    v_add_f32_dpp v69, v53, v52 row_ror:8 row_mask:0xf bank_mask:0xf
    v_add_f32_dpp v70, v57, v56 row_ror:8 row_mask:0xf bank_mask:0xf
    s_nop 0
    v_add_f32_dpp v71, v61, v60 row_ror:8 row_mask:0xf bank_mask:0xf
    s_mov_b32 exec_lo, 0xff00ff
    s_mov_b32 exec_hi, 0x0
    ds_write_b128 v13, v[64:67] offset:0
    ds_write_b128 v13, v[68:71] offset:16
    s_mov_b64 exec, -1
    v_mov_b32 v9, 0
    v_mov_b32 v10, 1
    s_mov_b32 exec_lo, 0x1
    s_mov_b32 exec_hi, 0x0
    ds_add_u32 v9, v10 offset:10752
    s_mov_b64 exec, -1
    s_waitcnt vmcnt(3)
    s_cbranch_vccnz L_sk2
    s_waitcnt vmcnt(2)
L_sk2:
    buffer_load_dwordx4 v[112:115], v2, s[24:27], s100 offen offset:0 nt
    s_cmp_lg_u32 s40, 0
    s_cbranch_scc1 L_noqpub
    v_and_b32 v13, 15, v0
    v_lshlrev_b32 v13, 4, v13
    v_lshl_or_b32 v13, v12, 13, v13
    s_lshl_b32 s57, s101, 14
    s_and_b32 s59, s43, 1
    s_lshl_b32 s59, s59, 12
    s_add_u32 s57, s57, s59
    s_lshr_b32 s59, s43, 1
    s_lshl_b32 s59, s59, 8
    s_add_u32 s57, s57, s59
    s_add_u32 s57, s57, 65536
    v_mov_b32 v9, 0
    s_mov_b32 s47, 400000
L_cnt3:
    ds_read_b32 v10, v9 offset:10752
    s_waitcnt lgkmcnt(0)
    v_readfirstlane_b32 s58, v10
    s_cmp_eq_u32 s58, 8
    s_cbranch_scc1 L_cnt3d
    s_sub_u32 s47, s47, 1
    s_cbranch_scc1 L_cnt3d
    s_sleep 1
    s_branch L_cnt3
L_cnt3d:
    ds_read_b128 v[32:35], v2 offset:0
    ds_read_b128 v[36:39], v2 offset:512
    ds_read_b128 v[40:43], v2 offset:1024
    ds_read_b128 v[44:47], v2 offset:1536
    ds_read_b128 v[48:51], v2 offset:2048
    ds_read_b128 v[52:55], v2 offset:2560
    ds_read_b128 v[56:59], v2 offset:3072
    ds_read_b128 v[60:63], v2 offset:3584
    s_waitcnt lgkmcnt(6)
    v_add_f32 v32, v32, v36
    v_add_f32 v33, v33, v37
    v_add_f32 v34, v34, v38
    v_add_f32 v35, v35, v39
    s_waitcnt lgkmcnt(5)
    v_add_f32 v32, v32, v40
    v_add_f32 v33, v33, v41
    v_add_f32 v34, v34, v42
    v_add_f32 v35, v35, v43
    s_waitcnt lgkmcnt(4)
    v_add_f32 v32, v32, v44
    v_add_f32 v33, v33, v45
    v_add_f32 v34, v34, v46
    v_add_f32 v35, v35, v47
    s_waitcnt lgkmcnt(3)
    v_add_f32 v32, v32, v48
    v_add_f32 v33, v33, v49
    v_add_f32 v34, v34, v50
    v_add_f32 v35, v35, v51
    s_waitcnt lgkmcnt(2)
    v_add_f32 v32, v32, v52
    v_add_f32 v33, v33, v53
    v_add_f32 v34, v34, v54
    v_add_f32 v35, v35, v55
    s_waitcnt lgkmcnt(1)
    v_add_f32 v32, v32, v56
    v_add_f32 v33, v33, v57
    v_add_f32 v34, v34, v58
    v_add_f32 v35, v35, v59
    s_waitcnt lgkmcnt(0)
    v_add_f32 v32, v32, v60
    v_add_f32 v33, v33, v61
    v_add_f32 v34, v34, v62
    v_add_f32 v35, v35, v63
    v_perm_b32 v32, v32, v8, s53
    v_perm_b32 v33, v33, v8, s54
    v_perm_b32 v34, v34, v8, s55
    v_perm_b32 v35, v35, v8, s56
    s_mov_b32 exec_lo, 0xffffffff
    s_mov_b32 exec_hi, 0x0
    buffer_store_dwordx4 v[32:35], v13, s[32:35], s57 offen sc1
    s_mov_b64 exec, -1
L_noqpub:
    s_waitcnt vmcnt(3)
    s_cbranch_vccnz L_sk4
    s_waitcnt vmcnt(2)
L_sk4:
    buffer_load_dwordx4 v[116:119], v2, s[24:27], s100 offen offset:1024 nt
    s_waitcnt vmcnt(3)
    s_cbranch_vccnz L_sk5
    s_waitcnt vmcnt(2)
L_sk5:
    buffer_load_dwordx4 v[120:123], v2, s[24:27], s100 offen offset:2048 nt
    v_mov_b32 v9, 0
    v_mov_b32 v10, 1
    s_mov_b32 exec_lo, 0x1
    s_mov_b32 exec_hi, 0x0
    ds_add_rtn_u32 v10, v9, v10 offset:10784
    s_waitcnt lgkmcnt(0)
    v_cmp_le_u32 vcc, s99, v10
    s_mov_b64 exec, -1
    s_waitcnt vmcnt(3)
    s_cbranch_vccnz L_sk6
    s_waitcnt vmcnt(2)
L_sk6:
    buffer_load_dwordx4 v[124:127], v2, s[24:27], s100 offen offset:3072 nt
    s_add_u32 s3, s43, s101
    s_and_b32 s3, s3, 7
    s_mul_i32 s3, s3, s96
    s_add_u32 s44, s45, s3
    s_waitcnt vmcnt(3)
    s_cbranch_vccnz L_sk7
    s_waitcnt vmcnt(2)
L_sk7:
    buffer_load_dwordx4 v[128:131], v1, s[12:15], s44 offen offset:0 nt
    s_waitcnt vmcnt(3)
    s_cbranch_vccnz L_sk8
    s_waitcnt vmcnt(2)
L_sk8:
    buffer_load_dwordx4 v[132:135], v1, s[12:15], s44 offen offset:128 nt
    s_waitcnt vmcnt(3)
    s_cbranch_vccnz L_sk9
    s_waitcnt vmcnt(2)
L_sk9:
    buffer_load_dwordx4 v[136:139], v1, s[12:15], s44 offen offset:2048 nt
    v_mov_b32 v9, 0
    v_mov_b32 v10, 1
    s_mov_b32 exec_lo, 0x1
    s_mov_b32 exec_hi, 0x0
    ds_add_rtn_u32 v10, v9, v10 offset:10788
    s_waitcnt lgkmcnt(0)
    v_cmp_le_u32 vcc, s99, v10
    s_mov_b64 exec, -1
    s_waitcnt vmcnt(3)
    s_cbranch_vccnz L_sk10
    s_waitcnt vmcnt(2)
L_sk10:
    buffer_load_dwordx4 v[140:143], v1, s[12:15], s44 offen offset:2176 nt
    s_add_u32 s3, s3, s96
    s_cmp_eq_u32 s3, s95
    s_cselect_b32 s3, 0, s3
    s_add_u32 s44, s45, s3
    s_waitcnt vmcnt(3)
    s_cbranch_vccnz L_sk11
    s_waitcnt vmcnt(2)
L_sk11:
    buffer_load_dwordx4 v[144:147], v1, s[12:15], s44 offen offset:0 nt
    s_waitcnt vmcnt(3)
    s_cbranch_vccnz L_sk12
    s_waitcnt vmcnt(2)
L_sk12:
    buffer_load_dwordx4 v[148:151], v1, s[12:15], s44 offen offset:128 nt
    s_waitcnt vmcnt(3)
    s_cbranch_vccnz L_sk13
    s_waitcnt vmcnt(2)
L_sk13:
    buffer_load_dwordx4 v[152:155], v1, s[12:15], s44 offen offset:2048 nt
    v_mov_b32 v9, 0
    v_mov_b32 v10, 1
    s_mov_b32 exec_lo, 0x1
    s_mov_b32 exec_hi, 0x0
    ds_add_rtn_u32 v10, v9, v10 offset:10792
    s_waitcnt lgkmcnt(0)
    v_cmp_le_u32 vcc, s99, v10
    s_mov_b64 exec, -1
    s_waitcnt vmcnt(3)
    s_cbranch_vccnz L_sk14
    s_waitcnt vmcnt(2)
L_sk14:
    buffer_load_dwordx4 v[156:159], v1, s[12:15], s44 offen offset:2176 nt
    s_add_u32 s3, s3, s96
    s_cmp_eq_u32 s3, s95
    s_cselect_b32 s3, 0, s3
    s_add_u32 s44, s45, s3
    s_waitcnt vmcnt(3)
    s_cbranch_vccnz L_sk15
    s_waitcnt vmcnt(2)
L_sk15:
    buffer_load_dwordx4 v[160:163], v1, s[12:15], s44 offen offset:0 nt
    s_waitcnt vmcnt(3)
    s_cbranch_vccnz L_sk16
    s_waitcnt vmcnt(2)
L_sk16:
    buffer_load_dwordx4 v[164:167], v1, s[12:15], s44 offen offset:128 nt
    s_waitcnt vmcnt(3)
    s_cbranch_vccnz L_sk17
    s_waitcnt vmcnt(2)
L_sk17:
    buffer_load_dwordx4 v[168:171], v1, s[12:15], s44 offen offset:2048 nt
    v_mov_b32 v9, 0
    v_mov_b32 v10, 1
    s_mov_b32 exec_lo, 0x1
    s_mov_b32 exec_hi, 0x0
    ds_add_rtn_u32 v10, v9, v10 offset:10796
    s_waitcnt lgkmcnt(0)
    v_cmp_le_u32 vcc, s99, v10
    s_mov_b64 exec, -1
    s_waitcnt vmcnt(3)
    s_cbranch_vccnz L_sk18
    s_waitcnt vmcnt(2)
L_sk18:
    buffer_load_dwordx4 v[172:175], v1, s[12:15], s44 offen offset:2176 nt
    s_add_u32 s3, s3, s96
    s_cmp_eq_u32 s3, s95
    s_cselect_b32 s3, 0, s3
    s_add_u32 s44, s45, s3
    s_waitcnt vmcnt(3)
    s_cbranch_vccnz L_sk19
    s_waitcnt vmcnt(2)
L_sk19:
    buffer_load_dwordx4 v[176:179], v1, s[12:15], s44 offen offset:0 nt
    s_lshl_b32 s58, s42, 1
    s_add_u32 s58, s58, s41
    s_lshl_b32 s58, s58, 13
    s_lshr_b32 s59, s40, 2
    s_lshl_b32 s59, s59, 16
    s_add_u32 s58, s58, s59
    s_and_b32 s59, s40, 3
    s_lshl_b32 s59, s59, 10
    s_add_u32 s58, s58, s59
    s_add_u32 s4, s58, 65536
    s_add_u32 s5, s4, 4096
    buffer_load_dwordx4 v[16:19], v2, s[32:35], s4 offen sc1
    buffer_load_dwordx4 v[20:23], v2, s[32:35], s5 offen sc1
    v_mov_b32 v9, 0
    v_mov_b32 v10, 1
    s_mov_b32 exec_lo, 0x1
    s_mov_b32 exec_hi, 0x0
    ds_add_rtn_u32 v10, v9, v10 offset:10800
    s_waitcnt lgkmcnt(0)
    v_cmp_le_u32 vcc, s99, v10
    s_mov_b64 exec, -1
    s_waitcnt vmcnt(3)
    s_cbranch_vccnz L_sk20
    s_waitcnt vmcnt(2)
L_sk20:
    buffer_load_dwordx4 v[180:183], v1, s[12:15], s44 offen offset:128 nt
    s_waitcnt vmcnt(3)
    s_cbranch_vccnz L_sk21
    s_waitcnt vmcnt(2)
L_sk21:
    buffer_load_dwordx4 v[184:187], v1, s[12:15], s44 offen offset:2048 nt
    s_waitcnt vmcnt(3)
    s_cbranch_vccnz L_sk22
    s_waitcnt vmcnt(2)
L_sk22:
    buffer_load_dwordx4 v[188:191], v1, s[12:15], s44 offen offset:2176 nt
    s_add_u32 s3, s3, s96
    s_cmp_eq_u32 s3, s95
    s_cselect_b32 s3, 0, s3
    s_add_u32 s44, s45, s3
    s_waitcnt vmcnt(3)
    s_cbranch_vccnz L_sk23
    s_waitcnt vmcnt(2)
L_sk23:
    buffer_load_dwordx4 v[192:195], v1, s[12:15], s44 offen offset:0 nt
    s_mov_b32 s47, 400000
L_qpoll:
    v_perm_b32 v9, v17, v16, s50
    v_perm_b32 v10, v19, v18, s51
    v_or_b32 v9, v9, v10
    v_cmp_ne_u32 s[6:7], s46, v9
    v_perm_b32 v9, v21, v20, s50
    v_perm_b32 v10, v23, v22, s51
    v_or_b32 v9, v9, v10
    v_cmp_ne_u32 s[58:59], s46, v9
    s_or_b64 s[6:7], s[6:7], s[58:59]
    s_cmp_eq_u64 s[6:7], 0
    s_cbranch_scc1 L_qdone
    s_sub_u32 s47, s47, 1
    s_cbranch_scc1 L_qdone
    s_sleep 8
    buffer_load_dwordx4 v[16:19], v2, s[32:35], s4 offen sc1
    buffer_load_dwordx4 v[20:23], v2, s[32:35], s5 offen sc1
    s_waitcnt vmcnt(0)
    s_branch L_qpoll
L_qdone:
    v_add_f32 v16, v16, v20
    v_add_f32 v17, v17, v21
    v_add_f32 v18, v18, v22
    v_add_f32 v19, v19, v23
    s_lshl_b32 s58, s40, 9
    v_lshlrev_b32 v13, 3, v0
    v_add_u32 v13, s58, v13
    v_cvt_pk_bf16_f32 v16, v16, v17
    v_cvt_pk_bf16_f32 v17, v18, v19
    ds_write_b64 v13, v[16:17] offset:4096
    v_mov_b32 v9, 0
    v_mov_b32 v10, 1
    s_mov_b32 exec_lo, 0x1
    s_mov_b32 exec_hi, 0x0
    ds_add_u32 v9, v10 offset:10756
    s_mov_b64 exec, -1
    v_mov_b32 v9, 0
    v_mov_b32 v10, 1
    s_mov_b32 exec_lo, 0x1
    s_mov_b32 exec_hi, 0x0
    ds_add_rtn_u32 v10, v9, v10 offset:10804
    s_waitcnt lgkmcnt(0)
    v_cmp_le_u32 vcc, s99, v10
    s_mov_b64 exec, -1
    s_waitcnt vmcnt(3)
    s_cbranch_vccnz L_sk24
    s_waitcnt vmcnt(2)
L_sk24:
    buffer_load_dwordx4 v[196:199], v1, s[12:15], s44 offen offset:128 nt
    s_waitcnt vmcnt(3)
    s_cbranch_vccnz L_sk25
    s_waitcnt vmcnt(2)
L_sk25:
    buffer_load_dwordx4 v[200:203], v1, s[12:15], s44 offen offset:2048 nt
    s_waitcnt vmcnt(3)
    s_cbranch_vccnz L_sk26
    s_waitcnt vmcnt(2)
L_sk26:
    buffer_load_dwordx4 v[204:207], v1, s[12:15], s44 offen offset:2176 nt
    s_add_u32 s3, s3, s96
    s_cmp_eq_u32 s3, s95
    s_cselect_b32 s3, 0, s3
    s_add_u32 s44, s45, s3
    s_waitcnt vmcnt(3)
    s_cbranch_vccnz L_sk27
    s_waitcnt vmcnt(2)
L_sk27:
    buffer_load_dwordx4 v[208:211], v1, s[12:15], s44 offen offset:0 nt
    v_and_b32 v13, 7, v0
    v_lshlrev_b32 v28, 4, v13
    v_lshl_or_b32 v28, v13, 9, v28
    v_lshl_or_b32 v28, v12, 7, v28
    s_lshl_b32 s58, s40, 12
    v_add_u32 v28, s58, v28
    v_lshlrev_b32 v13, 8, v13
    v_lshl_or_b32 v13, v12, 4, v13
    v_bfe_u32 v14, v0, 3, 1
    v_lshl_or_b32 v13, v14, 6, v13
    s_lshl_b32 s58, s97, 11
    v_add_u32 v14, s58, v13
    v_mov_b32 v9, 0
    s_mov_b32 s47, 400000
L_cnt28:
    ds_read_b32 v10, v9 offset:10756
    s_waitcnt lgkmcnt(0)
    v_readfirstlane_b32 s58, v10
    s_cmp_eq_u32 s58, 8
    s_cbranch_scc1 L_cnt28d
    s_sub_u32 s47, s47, 1
    s_cbranch_scc1 L_cnt28d
    s_sleep 1
    s_branch L_cnt28
L_cnt28d:
    ds_read_b128 v[56:59], v13 offset:4096
    ds_read_b128 v[60:63], v13 offset:4224
    ds_read_b128 v[48:51], v14 offset:4096
    ds_read_b128 v[52:55], v14 offset:4224
    v_mov_b32 v9, 0
    v_mov_b32 v10, 1
    s_mov_b32 exec_lo, 0x1
    s_mov_b32 exec_hi, 0x0
    ds_add_rtn_u32 v10, v9, v10 offset:10808
    s_waitcnt lgkmcnt(0)
    v_cmp_le_u32 vcc, s99, v10
    s_mov_b64 exec, -1
    s_waitcnt vmcnt(3)
    s_cbranch_vccnz L_sk29
    s_waitcnt vmcnt(2)
L_sk29:
    buffer_load_dwordx4 v[212:215], v1, s[12:15], s44 offen offset:128 nt
    s_waitcnt lgkmcnt(2)
    v_mfma_f32_16x16x32_bf16 v[32:35], v[96:99], v[56:59], 0
    v_mfma_f32_16x16x32_bf16 v[36:39], v[104:107], v[56:59], 0
    v_mfma_f32_16x16x32_bf16 v[32:35], v[100:103], v[60:63], v[32:35]
    v_mfma_f32_16x16x32_bf16 v[36:39], v[108:111], v[60:63], v[36:39]
    s_lshl_b32 s58, s40, 2
    v_lshlrev_b32 v31, 5, v0
    v_add_u32 v31, s58, v31
    s_nop 4
    v_add_f32_dpp v16, v33, v32 row_ror:8 row_mask:0xf bank_mask:0xf
    v_add_f32_dpp v17, v35, v34 row_ror:8 row_mask:0xf bank_mask:0xf
    v_add_f32_dpp v18, v37, v36 row_ror:8 row_mask:0xf bank_mask:0xf
    v_add_f32_dpp v19, v39, v38 row_ror:8 row_mask:0xf bank_mask:0xf
    s_waitcnt vmcnt(3)
    s_cbranch_vccnz L_sk30
    s_waitcnt vmcnt(2)
L_sk30:
    buffer_load_dwordx4 v[216:219], v1, s[12:15], s44 offen offset:2048 nt
    s_waitcnt lgkmcnt(0)
    v_mfma_f32_16x16x32_bf16 v[32:35], v[128:131], v[48:51], 0
    v_mfma_f32_16x16x32_bf16 v[36:39], v[136:139], v[48:51], 0
    v_mfma_f32_16x16x32_bf16 v[40:43], v[144:147], v[48:51], 0
    v_mfma_f32_16x16x32_bf16 v[44:47], v[152:155], v[48:51], 0
    v_mfma_f32_16x16x32_bf16 v[32:35], v[132:135], v[52:55], v[32:35]
    v_mfma_f32_16x16x32_bf16 v[36:39], v[140:143], v[52:55], v[36:39]
    v_mfma_f32_16x16x32_bf16 v[40:43], v[148:151], v[52:55], v[40:43]
    v_mfma_f32_16x16x32_bf16 v[44:47], v[156:159], v[52:55], v[44:47]
    s_nop 4
    v_add_f32_dpp v64, v33, v32 row_ror:8 row_mask:0xf bank_mask:0xf
    v_add_f32_dpp v65, v35, v34 row_ror:8 row_mask:0xf bank_mask:0xf
    v_add_f32_dpp v66, v37, v36 row_ror:8 row_mask:0xf bank_mask:0xf
    v_add_f32_dpp v67, v39, v38 row_ror:8 row_mask:0xf bank_mask:0xf
    v_add_f32_dpp v68, v41, v40 row_ror:8 row_mask:0xf bank_mask:0xf
    v_add_f32_dpp v69, v43, v42 row_ror:8 row_mask:0xf bank_mask:0xf
    s_nop 0
    v_add_f32_dpp v70, v45, v44 row_ror:8 row_mask:0xf bank_mask:0xf
    v_add_f32_dpp v71, v47, v46 row_ror:8 row_mask:0xf bank_mask:0xf
    s_waitcnt vmcnt(3)
    s_cbranch_vccnz L_sk31
    s_waitcnt vmcnt(2)
L_sk31:
    buffer_load_dwordx4 v[220:223], v1, s[12:15], s44 offen offset:2176 nt
    v_mfma_f32_16x16x32_bf16 v[32:35], v[160:163], v[48:51], 0
    v_mfma_f32_16x16x32_bf16 v[36:39], v[168:171], v[48:51], 0
    v_mfma_f32_16x16x32_bf16 v[40:43], v[176:179], v[48:51], 0
    v_mfma_f32_16x16x32_bf16 v[44:47], v[184:187], v[48:51], 0
    v_mfma_f32_16x16x32_bf16 v[32:35], v[164:167], v[52:55], v[32:35]
    v_mfma_f32_16x16x32_bf16 v[36:39], v[172:175], v[52:55], v[36:39]
    v_mfma_f32_16x16x32_bf16 v[40:43], v[180:183], v[52:55], v[40:43]
    v_mfma_f32_16x16x32_bf16 v[44:47], v[188:191], v[52:55], v[44:47]
    s_nop 4
    v_add_f32_dpp v72, v33, v32 row_ror:8 row_mask:0xf bank_mask:0xf
    v_add_f32_dpp v73, v35, v34 row_ror:8 row_mask:0xf bank_mask:0xf
    v_add_f32_dpp v74, v37, v36 row_ror:8 row_mask:0xf bank_mask:0xf
    v_add_f32_dpp v75, v39, v38 row_ror:8 row_mask:0xf bank_mask:0xf
    v_add_f32_dpp v76, v41, v40 row_ror:8 row_mask:0xf bank_mask:0xf
    v_add_f32_dpp v77, v43, v42 row_ror:8 row_mask:0xf bank_mask:0xf
    s_nop 0
    v_add_f32_dpp v78, v45, v44 row_ror:8 row_mask:0xf bank_mask:0xf
    v_add_f32_dpp v79, v47, v46 row_ror:8 row_mask:0xf bank_mask:0xf
    s_add_u32 s3, s3, s96
    s_cmp_eq_u32 s3, s95
    s_cselect_b32 s3, 0, s3
    s_add_u32 s44, s45, s3
    s_waitcnt vmcnt(3)
    s_cbranch_vccnz L_sk32
    s_waitcnt vmcnt(2)
L_sk32:
    buffer_load_dwordx4 v[224:227], v1, s[12:15], s44 offen offset:0 nt
    v_mov_b32 v9, 0
    v_mov_b32 v10, 1
    s_mov_b32 exec_lo, 0x1
    s_mov_b32 exec_hi, 0x0
    ds_add_rtn_u32 v10, v9, v10 offset:10812
    s_waitcnt lgkmcnt(0)
    v_cmp_le_u32 vcc, s99, v10
    s_mov_b64 exec, -1
    s_waitcnt vmcnt(3)
    s_cbranch_vccnz L_sk33
    s_waitcnt vmcnt(2)
L_sk33:
    buffer_load_dwordx4 v[228:231], v1, s[12:15], s44 offen offset:128 nt
    s_waitcnt vmcnt(3)
    s_cbranch_vccnz L_sk34
    s_waitcnt vmcnt(2)
L_sk34:
    buffer_load_dwordx4 v[232:235], v1, s[12:15], s44 offen offset:2048 nt
    s_waitcnt vmcnt(3)
    s_cbranch_vccnz L_sk35
    s_waitcnt vmcnt(2)
L_sk35:
    buffer_load_dwordx4 v[236:239], v1, s[12:15], s44 offen offset:2176 nt
    s_add_u32 s3, s3, s96
    s_cmp_eq_u32 s3, s95
    s_cselect_b32 s3, 0, s3
    s_add_u32 s44, s45, s3
    s_waitcnt vmcnt(3)
    s_cbranch_vccnz L_sk36
    s_waitcnt vmcnt(2)
L_sk36:
    buffer_load_dwordx4 v[240:243], v1, s[12:15], s44 offen offset:0 nt
    v_mfma_f32_16x16x32_bf16 v[32:35], v[192:195], v[48:51], 0
    v_mfma_f32_16x16x32_bf16 v[36:39], v[200:203], v[48:51], 0
    v_mfma_f32_16x16x32_bf16 v[40:43], v[208:211], v[48:51], 0
    v_mfma_f32_16x16x32_bf16 v[44:47], v[216:219], v[48:51], 0
    v_mfma_f32_16x16x32_bf16 v[32:35], v[196:199], v[52:55], v[32:35]
    v_mfma_f32_16x16x32_bf16 v[36:39], v[204:207], v[52:55], v[36:39]
    v_mfma_f32_16x16x32_bf16 v[40:43], v[212:215], v[52:55], v[40:43]
    v_mfma_f32_16x16x32_bf16 v[44:47], v[220:223], v[52:55], v[44:47]
    s_nop 4
    v_add_f32_dpp v80, v33, v32 row_ror:8 row_mask:0xf bank_mask:0xf
    v_add_f32_dpp v81, v35, v34 row_ror:8 row_mask:0xf bank_mask:0xf
    v_add_f32_dpp v82, v37, v36 row_ror:8 row_mask:0xf bank_mask:0xf
    v_add_f32_dpp v83, v39, v38 row_ror:8 row_mask:0xf bank_mask:0xf
    v_add_f32_dpp v84, v41, v40 row_ror:8 row_mask:0xf bank_mask:0xf
    v_add_f32_dpp v85, v43, v42 row_ror:8 row_mask:0xf bank_mask:0xf
    s_nop 0
    v_add_f32_dpp v86, v45, v44 row_ror:8 row_mask:0xf bank_mask:0xf
    v_add_f32_dpp v87, v47, v46 row_ror:8 row_mask:0xf bank_mask:0xf
    v_mov_b32 v9, 0
    v_mov_b32 v10, 1
    s_mov_b32 exec_lo, 0x1
    s_mov_b32 exec_hi, 0x0
    ds_add_rtn_u32 v10, v9, v10 offset:10816
    s_waitcnt lgkmcnt(0)
    v_cmp_le_u32 vcc, s99, v10
    s_mov_b64 exec, -1
    s_waitcnt vmcnt(3)
    s_cbranch_vccnz L_sk37
    s_waitcnt vmcnt(2)
L_sk37:
    buffer_load_dwordx4 v[244:247], v1, s[12:15], s44 offen offset:128 nt
    s_waitcnt vmcnt(3)
    s_cbranch_vccnz L_sk38
    s_waitcnt vmcnt(2)
L_sk38:
    buffer_load_dwordx4 v[248:251], v1, s[12:15], s44 offen offset:2048 nt
    s_waitcnt vmcnt(3)
    s_cbranch_vccnz L_sk39
    s_waitcnt vmcnt(2)
L_sk39:
    buffer_load_dwordx4 v[252:255], v1, s[12:15], s44 offen offset:2176 nt
    s_add_u32 s3, s43, s101
    s_and_b32 s3, s3, 7
    s_mul_i32 s3, s3, s96
    s_add_u32 s44, s45, s3
    s_waitcnt vmcnt(3)
    s_cbranch_vccnz L_sk40
    s_waitcnt vmcnt(2)
L_sk40:
    buffer_load_dwordx4 v[128:131], v2, s[16:19], s44 offen offset:0 nt
    v_mov_b32 v9, 0
    v_mov_b32 v10, 1
    s_mov_b32 exec_lo, 0x1
    s_mov_b32 exec_hi, 0x0
    ds_add_rtn_u32 v10, v9, v10 offset:10820
    s_waitcnt lgkmcnt(0)
    v_cmp_le_u32 vcc, s99, v10
    s_mov_b64 exec, -1
    s_waitcnt vmcnt(3)
    s_cbranch_vccnz L_sk41
    s_waitcnt vmcnt(2)
L_sk41:
    buffer_load_dwordx4 v[132:135], v2, s[16:19], s44 offen offset:1024 nt
    s_waitcnt vmcnt(3)
    s_cbranch_vccnz L_sk42
    s_waitcnt vmcnt(2)
L_sk42:
    buffer_load_dwordx4 v[136:139], v2, s[16:19], s44 offen offset:2048 nt
    s_waitcnt vmcnt(3)
    s_cbranch_vccnz L_sk43
    s_waitcnt vmcnt(2)
L_sk43:
    buffer_load_dwordx4 v[140:143], v2, s[16:19], s44 offen offset:3072 nt
    v_mfma_f32_16x16x32_bf16 v[32:35], v[224:227], v[48:51], 0
    v_mfma_f32_16x16x32_bf16 v[36:39], v[232:235], v[48:51], 0
    v_mfma_f32_16x16x32_bf16 v[40:43], v[240:243], v[48:51], 0
    v_mfma_f32_16x16x32_bf16 v[44:47], v[248:251], v[48:51], 0
    v_mfma_f32_16x16x32_bf16 v[32:35], v[228:231], v[52:55], v[32:35]
    v_mfma_f32_16x16x32_bf16 v[36:39], v[236:239], v[52:55], v[36:39]
    v_mfma_f32_16x16x32_bf16 v[40:43], v[244:247], v[52:55], v[40:43]
    v_mfma_f32_16x16x32_bf16 v[44:47], v[252:255], v[52:55], v[44:47]
    s_nop 4
    v_add_f32_dpp v88, v33, v32 row_ror:8 row_mask:0xf bank_mask:0xf
    v_add_f32_dpp v89, v35, v34 row_ror:8 row_mask:0xf bank_mask:0xf
    v_add_f32_dpp v90, v37, v36 row_ror:8 row_mask:0xf bank_mask:0xf
    v_add_f32_dpp v91, v39, v38 row_ror:8 row_mask:0xf bank_mask:0xf
    v_add_f32_dpp v92, v41, v40 row_ror:8 row_mask:0xf bank_mask:0xf
    v_add_f32_dpp v93, v43, v42 row_ror:8 row_mask:0xf bank_mask:0xf
    s_nop 0
    v_add_f32_dpp v94, v45, v44 row_ror:8 row_mask:0xf bank_mask:0xf
    v_add_f32_dpp v95, v47, v46 row_ror:8 row_mask:0xf bank_mask:0xf
    s_add_u32 s3, s3, s96
    s_cmp_eq_u32 s3, s95
    s_cselect_b32 s3, 0, s3
    s_add_u32 s44, s45, s3
    s_waitcnt vmcnt(3)
    s_cbranch_vccnz L_sk44
    s_waitcnt vmcnt(2)
L_sk44:
    buffer_load_dwordx4 v[144:147], v2, s[16:19], s44 offen offset:0 nt
    v_max3_f32 v22, v64, v65, v66
    v_max3_f32 v26, v67, v68, v69
    v_max3_f32 v22, v22, v70, v71
    v_max3_f32 v26, v26, v72, v73
    v_max3_f32 v22, v22, v74, v75
    v_max3_f32 v26, v26, v76, v77
    v_max3_f32 v22, v22, v78, v79
    v_max3_f32 v26, v26, v80, v81
    v_max3_f32 v22, v22, v82, v83
    v_max3_f32 v26, v26, v84, v85
    v_max3_f32 v22, v22, v86, v87
    v_max3_f32 v26, v26, v88, v89
    v_max3_f32 v22, v22, v90, v91
    v_max3_f32 v26, v26, v92, v93
    v_max3_f32 v22, v22, v94, v95
    v_max3_f32 v23, v16, v17, v18
    v_max_f32 v22, v22, v26
    v_max_f32 v23, v23, v19
    s_cmp_eq_u32 s97, 1
    s_cbranch_scc1 L_twomax
    v_max_f32 v22, v22, v23
    v_mov_b32 v26, v22
    s_nop 1
    v_permlane16_swap_b32 v22, v26
    v_max_f32 v22, v22, v26
    v_mov_b32 v26, v22
    s_nop 1
    v_permlane32_swap_b32 v22, v26
    v_max_f32 v22, v22, v26
    v_mov_b32 v23, v22
    s_branch L_onemax
L_twomax:
    v_mov_b32 v26, v22
    s_nop 1
    v_permlane16_swap_b32 v22, v26
    v_max_f32 v22, v22, v26
    v_mov_b32 v26, v22
    s_nop 1
    v_permlane32_swap_b32 v22, v26
    v_max_f32 v22, v22, v26
    v_mov_b32 v26, v23
    s_nop 1
    v_permlane16_swap_b32 v23, v26
    v_max_f32 v23, v23, v26
    v_mov_b32 v26, v23
    s_nop 1
    v_permlane32_swap_b32 v23, v26
    v_max_f32 v23, v23, v26
L_onemax:
    v_mul_f32 v22, s52, v22
    v_mul_f32 v23, s52, v23
    v_mov_b32 v9, 0
    v_mov_b32 v10, 1
    s_mov_b32 exec_lo, 0x1
    s_mov_b32 exec_hi, 0x0
    ds_add_rtn_u32 v10, v9, v10 offset:10824
    s_waitcnt lgkmcnt(0)
    v_cmp_le_u32 vcc, s99, v10
    s_mov_b64 exec, -1
    s_waitcnt vmcnt(3)
    s_cbranch_vccnz L_sk45
    s_waitcnt vmcnt(2)
L_sk45:
    buffer_load_dwordx4 v[148:151], v2, s[16:19], s44 offen offset:1024 nt
    v_fma_f32 v16, v16, s52, -v23
    v_fma_f32 v17, v17, s52, -v23
    v_fma_f32 v18, v18, s52, -v23
    v_fma_f32 v19, v19, s52, -v23
    v_exp_f32 v16, v16
    v_exp_f32 v17, v17
    v_exp_f32 v18, v18
    v_exp_f32 v19, v19
    v_add_f32 v25, v16, v17
    v_add_f32 v27, v18, v19
    v_cvt_pk_bf16_f32 v20, v16, v17
    v_cvt_pk_bf16_f32 v21, v18, v19
    v_add_f32 v25, v25, v27
    v_fma_f32 v64, v64, s52, -v22
    v_fma_f32 v65, v65, s52, -v22
    v_fma_f32 v66, v66, s52, -v22
    v_fma_f32 v67, v67, s52, -v22
    v_fma_f32 v68, v68, s52, -v22
    v_fma_f32 v69, v69, s52, -v22
    v_fma_f32 v70, v70, s52, -v22
    v_fma_f32 v71, v71, s52, -v22
    v_exp_f32 v64, v64
    v_exp_f32 v65, v65
    v_exp_f32 v66, v66
    v_exp_f32 v67, v67
    v_exp_f32 v68, v68
    v_exp_f32 v69, v69
    v_exp_f32 v70, v70
    v_exp_f32 v71, v71
    v_add_f32 v24, v64, v65
    v_add_f32 v26, v66, v67
    v_add_f32 v24, v24, v68
    v_add_f32 v26, v26, v69
    v_add_f32 v24, v24, v70
    v_add_f32 v26, v26, v71
    v_cvt_pk_bf16_f32 v64, v64, v65
    v_cvt_pk_bf16_f32 v65, v66, v67
    v_cvt_pk_bf16_f32 v66, v68, v69
    v_cvt_pk_bf16_f32 v67, v70, v71
    s_waitcnt vmcnt(3)
    s_cbranch_vccnz L_sk46
    s_waitcnt vmcnt(2)
L_sk46:
    buffer_load_dwordx4 v[152:155], v2, s[16:19], s44 offen offset:2048 nt
    v_fma_f32 v72, v72, s52, -v22
    v_fma_f32 v73, v73, s52, -v22
    v_fma_f32 v74, v74, s52, -v22
    v_fma_f32 v75, v75, s52, -v22
    v_fma_f32 v76, v76, s52, -v22
    v_fma_f32 v77, v77, s52, -v22
    v_fma_f32 v78, v78, s52, -v22
    v_fma_f32 v79, v79, s52, -v22
    v_exp_f32 v72, v72
    v_exp_f32 v73, v73
    v_exp_f32 v74, v74
    v_exp_f32 v75, v75
    v_exp_f32 v76, v76
    v_exp_f32 v77, v77
    v_exp_f32 v78, v78
    v_exp_f32 v79, v79
    v_add_f32 v24, v24, v72
    v_add_f32 v26, v26, v73
    v_add_f32 v24, v24, v74
    v_add_f32 v26, v26, v75
    v_add_f32 v24, v24, v76
    v_add_f32 v26, v26, v77
    v_add_f32 v24, v24, v78
    v_add_f32 v26, v26, v79
    v_cvt_pk_bf16_f32 v68, v72, v73
    v_cvt_pk_bf16_f32 v69, v74, v75
    v_cvt_pk_bf16_f32 v70, v76, v77
    v_cvt_pk_bf16_f32 v71, v78, v79
    s_waitcnt vmcnt(3)
    s_cbranch_vccnz L_sk47
    s_waitcnt vmcnt(2)
L_sk47:
    buffer_load_dwordx4 v[156:159], v2, s[16:19], s44 offen offset:3072 nt
    v_fma_f32 v80, v80, s52, -v22
    v_fma_f32 v81, v81, s52, -v22
    v_fma_f32 v82, v82, s52, -v22
    v_fma_f32 v83, v83, s52, -v22
    v_fma_f32 v84, v84, s52, -v22
    v_fma_f32 v85, v85, s52, -v22
    v_fma_f32 v86, v86, s52, -v22
    v_fma_f32 v87, v87, s52, -v22
    v_exp_f32 v80, v80
    v_exp_f32 v81, v81
    v_exp_f32 v82, v82
    v_exp_f32 v83, v83
    v_exp_f32 v84, v84
    v_exp_f32 v85, v85
    v_exp_f32 v86, v86
    v_exp_f32 v87, v87
    v_add_f32 v24, v24, v80
    v_add_f32 v26, v26, v81
    v_add_f32 v24, v24, v82
    v_add_f32 v26, v26, v83
    v_add_f32 v24, v24, v84
    v_add_f32 v26, v26, v85
    v_add_f32 v24, v24, v86
    v_add_f32 v26, v26, v87
    v_cvt_pk_bf16_f32 v72, v80, v81
    v_cvt_pk_bf16_f32 v73, v82, v83
    v_cvt_pk_bf16_f32 v74, v84, v85
    v_cvt_pk_bf16_f32 v75, v86, v87
    s_add_u32 s3, s3, s96
    s_cmp_eq_u32 s3, s95
    s_cselect_b32 s3, 0, s3
    s_add_u32 s44, s45, s3
    s_waitcnt vmcnt(3)
    s_cbranch_vccnz L_sk48
    s_waitcnt vmcnt(2)
L_sk48:
    buffer_load_dwordx4 v[160:163], v2, s[16:19], s44 offen offset:0 nt
    v_fma_f32 v88, v88, s52, -v22
    v_fma_f32 v89, v89, s52, -v22
    v_fma_f32 v90, v90, s52, -v22
    v_fma_f32 v91, v91, s52, -v22
    v_fma_f32 v92, v92, s52, -v22
    v_fma_f32 v93, v93, s52, -v22
    v_fma_f32 v94, v94, s52, -v22
    v_fma_f32 v95, v95, s52, -v22
    v_exp_f32 v88, v88
    v_exp_f32 v89, v89
    v_exp_f32 v90, v90
    v_exp_f32 v91, v91
    v_exp_f32 v92, v92
    v_exp_f32 v93, v93
    v_exp_f32 v94, v94
    v_exp_f32 v95, v95
    v_add_f32 v24, v24, v88
    v_add_f32 v26, v26, v89
    v_add_f32 v24, v24, v90
    v_add_f32 v26, v26, v91
    v_add_f32 v24, v24, v92
    v_add_f32 v26, v26, v93
    v_add_f32 v24, v24, v94
    v_add_f32 v26, v26, v95
    v_cvt_pk_bf16_f32 v76, v88, v89
    v_cvt_pk_bf16_f32 v77, v90, v91
    v_cvt_pk_bf16_f32 v78, v92, v93
    v_cvt_pk_bf16_f32 v79, v94, v95
    v_mov_b32 v9, 0
    v_mov_b32 v10, 1
    s_mov_b32 exec_lo, 0x1
    s_mov_b32 exec_hi, 0x0
    ds_add_rtn_u32 v10, v9, v10 offset:10828
    s_waitcnt lgkmcnt(0)
    v_cmp_le_u32 vcc, 4, v10
    s_mov_b64 exec, -1
    s_waitcnt vmcnt(3)
    s_cbranch_vccnz L_sk49
    s_waitcnt vmcnt(2)
L_sk49:
    buffer_load_dwordx4 v[164:167], v2, s[16:19], s44 offen offset:1024 nt
    v_add_f32 v24, v24, v26
    s_cmp_eq_u32 s97, 1
    s_cbranch_scc1 L_twosum
    v_add_f32 v24, v24, v25
    s_branch L_onesum
L_twosum:
    v_mov_b32 v26, v25
    s_nop 1
    v_permlane16_swap_b32 v25, v26
    v_add_f32 v25, v25, v26
    v_mov_b32 v26, v25
    s_nop 1
    v_permlane32_swap_b32 v25, v26
    v_add_f32 v25, v25, v26
    s_mov_b32 exec_lo, 0xff
    s_mov_b32 exec_hi, 0x0
    ds_write_b32 v31, v23 offset:8704
    ds_write_b32 v31, v25 offset:8960
    s_mov_b64 exec, -1
L_onesum:
    v_mov_b32 v26, v24
    s_nop 1
    v_permlane16_swap_b32 v24, v26
    v_add_f32 v24, v24, v26
    v_mov_b32 v26, v24
    s_nop 1
    v_permlane32_swap_b32 v24, v26
    v_add_f32 v24, v24, v26
    s_mov_b32 exec_lo, 0xff
    s_mov_b32 exec_hi, 0x0
    ds_write_b32 v31, v22 offset:8192
    ds_write_b32 v31, v24 offset:8448
    s_mov_b64 exec, -1
    s_waitcnt vmcnt(3)
    s_cbranch_vccnz L_sk50
    s_waitcnt vmcnt(2)
L_sk50:
    buffer_load_dwordx4 v[168:171], v2, s[16:19], s44 offen offset:2048 nt
    v_perm_b32 v80, v116, v112, s48
    v_perm_b32 v81, v124, v120, s48
    v_perm_b32 v84, v116, v112, s49
    v_perm_b32 v85, v124, v120, s49
    v_mfma_f32_16x16x16_bf16 v[32:35], v[80:81], v[20:21], 0
    v_perm_b32 v88, v117, v113, s48
    v_perm_b32 v89, v125, v121, s48
    v_mfma_f32_16x16x16_bf16 v[36:39], v[84:85], v[20:21], 0
    v_perm_b32 v92, v117, v113, s49
    v_perm_b32 v93, v125, v121, s49
    v_mfma_f32_16x16x16_bf16 v[40:43], v[88:89], v[20:21], 0
    v_perm_b32 v80, v118, v114, s48
    v_perm_b32 v81, v126, v122, s48
    v_mfma_f32_16x16x16_bf16 v[44:47], v[92:93], v[20:21], 0
    v_perm_b32 v84, v118, v114, s49
    v_perm_b32 v85, v126, v122, s49
    v_mfma_f32_16x16x16_bf16 v[48:51], v[80:81], v[20:21], 0
    v_perm_b32 v88, v119, v115, s48
    v_perm_b32 v89, v127, v123, s48
    v_mfma_f32_16x16x16_bf16 v[52:55], v[84:85], v[20:21], 0
    v_perm_b32 v92, v119, v115, s49
    v_perm_b32 v93, v127, v123, s49
    v_mfma_f32_16x16x16_bf16 v[56:59], v[88:89], v[20:21], 0
    s_nop 1
    v_mfma_f32_16x16x16_bf16 v[60:63], v[92:93], v[20:21], 0
    s_waitcnt vmcnt(3)
    s_cbranch_vccnz L_sk51
    s_waitcnt vmcnt(2)
L_sk51:
    buffer_load_dwordx4 v[172:175], v2, s[16:19], s44 offen offset:3072 nt
    s_cmp_eq_u32 s97, 0
    s_cbranch_scc1 L_noYw
    s_nop 3
    s_mov_b32 exec_lo, 0xff00ff
    s_mov_b32 exec_hi, 0xff00ff
    ds_write_b128 v28, v[32:35] offset:45056
    v_xor_b32 v30, 16, v28
    ds_write_b128 v30, v[36:39] offset:45056
    v_xor_b32 v29, 32, v28
    ds_write_b128 v29, v[40:43] offset:45056
    v_xor_b32 v30, 48, v28
    ds_write_b128 v30, v[44:47] offset:45056
    v_xor_b32 v29, 64, v28
    ds_write_b128 v29, v[48:51] offset:45056
    v_xor_b32 v30, 80, v28
    ds_write_b128 v30, v[52:55] offset:45056
    v_xor_b32 v29, 96, v28
    ds_write_b128 v29, v[56:59] offset:45056
    v_xor_b32 v30, 112, v28
    ds_write_b128 v30, v[60:63] offset:45056
    s_mov_b64 exec, -1
L_noYw:
    v_mov_b32 v9, 0
    v_mov_b32 v10, 1
    s_mov_b32 exec_lo, 0x1
    s_mov_b32 exec_hi, 0x0
    ds_add_u32 v9, v10 offset:10760
    s_mov_b64 exec, -1
    s_add_u32 s3, s3, s96
    s_cmp_eq_u32 s3, s95
    s_cselect_b32 s3, 0, s3
    s_add_u32 s44, s45, s3
    s_waitcnt vmcnt(3)
    s_cbranch_vccnz L_sk52
    s_waitcnt vmcnt(2)
L_sk52:
    buffer_load_dwordx4 v[176:179], v2, s[16:19], s44 offen offset:0 nt
    s_and_b32 s58, s40, 3
    s_lshl_b32 s58, s58, 6
    v_add_u32 v9, s58, v0
    v_lshrrev_b32 v10, 5, v9
    v_lshrrev_b32 v11, 3, v9
    v_and_b32 v13, 7, v0
    v_xor_b32 v14, v13, v10
    v_lshlrev_b32 v14, 4, v14
    v_lshl_or_b32 v14, v11, 7, v14
    v_lshlrev_b32 v15, 5, v10
    v_and_b32 v13, 15, v0
    v_lshlrev_b32 v13, 4, v13
    v_lshrrev_b32 v11, 4, v9
    v_lshl_or_b32 v11, v11, 14, v13
    s_cmp_lt_u32 s40, 4
    s_cselect_b32 s57, s97, 0
    s_lshl_b32 s59, s57, 2
    s_add_u32 s59, s59, s42
    s_mul_i32 s57, s57, 28
    s_lshl_b32 s58, s41, 5
    s_add_u32 s58, s58, s43
    s_sub_u32 s58, s58, s57
    s_lshl_b32 s20, s59, 18
    s_lshl_b32 s57, s58, 8
    s_add_u32 s20, s20, s57
    s_add_u32 s20, s20, 1048576
    s_lshl_b32 s21, s59, 13
    s_lshl_b32 s57, s58, 7
    s_add_u32 s21, s21, s57
    s_add_u32 s21, s21, 196608
    v_and_b32 v3, 7, v0
    v_lshlrev_b32 v3, 4, v3
    v_lshrrev_b32 v13, 3, v0
    v_lshl_or_b32 v3, v13, 11, v3
    s_lshl_b32 s58, s42, 4
    s_lshr_b32 s59, s43, 1
    s_add_u32 s58, s58, s59
    s_lshl_b32 s100, s58, 17
    s_and_b32 s59, s43, 1
    s_lshl_b32 s59, s59, 3
    s_add_u32 s59, s59, s40
    s_lshl_b32 s59, s59, 7
    s_add_u32 s100, s100, s59
    v_mov_b32 v9, 0
    v_mov_b32 v10, 1
    s_mov_b32 exec_lo, 0x1
    s_mov_b32 exec_hi, 0x0
    ds_add_rtn_u32 v10, v9, v10 offset:10832
    s_waitcnt lgkmcnt(0)
    v_cmp_le_u32 vcc, 4, v10
    s_mov_b64 exec, -1
    s_waitcnt vmcnt(3)
    s_cbranch_vccnz L_sk53
    s_waitcnt vmcnt(2)
L_sk53:
    buffer_load_dwordx4 v[180:183], v2, s[16:19], s44 offen offset:1024 nt
    s_waitcnt vmcnt(3)
    s_cbranch_vccnz L_sk54
    s_waitcnt vmcnt(2)
L_sk54:
    buffer_load_dwordx4 v[184:187], v2, s[16:19], s44 offen offset:2048 nt
    s_cmp_lt_u32 s40, 4
    s_cbranch_scc1 L_notB
    s_cmp_eq_u32 s97, 0
    s_cbranch_scc1 L_dutydone
    v_mov_b32 v9, 0
    s_mov_b32 s47, 400000
L_cnt55:
    ds_read_b32 v10, v9 offset:10760
    s_waitcnt lgkmcnt(0)
    v_readfirstlane_b32 s58, v10
    s_cmp_eq_u32 s58, 8
    s_cbranch_scc1 L_cnt55d
    s_sub_u32 s47, s47, 1
    s_cbranch_scc1 L_cnt55d
    s_sleep 1
    s_branch L_cnt55
L_cnt55d:
    ds_read_b128 v[32:35], v15 offset:8704
    ds_read_b128 v[36:39], v15 offset:8720
    v_add_u32 v13, 32768, v14
    ds_read_b128 v[96:99], v13 offset:12288
    ds_read_b128 v[100:103], v13 offset:16384
    ds_read_b128 v[104:107], v13 offset:20480
    ds_read_b128 v[108:111], v13 offset:24576
    ds_read_b128 v[112:115], v13 offset:28672
    ds_read_b128 v[116:119], v13 offset:32768
    ds_read_b128 v[120:123], v13 offset:36864
    ds_read_b128 v[124:127], v13 offset:40960
    ds_read_b128 v[40:43], v15 offset:8960
    ds_read_b128 v[44:47], v15 offset:8976
    s_waitcnt lgkmcnt(10)
    v_max3_f32 v48, v32, v33, v34
    v_max3_f32 v49, v35, v36, v37
    v_max3_f32 v48, v48, v38, v39
    v_max_f32 v48, v48, v49
    v_sub_f32 v32, v32, v48
    v_sub_f32 v33, v33, v48
    v_sub_f32 v34, v34, v48
    v_sub_f32 v35, v35, v48
    v_sub_f32 v36, v36, v48
    v_sub_f32 v37, v37, v48
    v_sub_f32 v38, v38, v48
    v_sub_f32 v39, v39, v48
    v_exp_f32 v32, v32
    v_exp_f32 v33, v33
    v_exp_f32 v34, v34
    v_exp_f32 v35, v35
    v_exp_f32 v36, v36
    v_exp_f32 v37, v37
    v_exp_f32 v38, v38
    v_exp_f32 v39, v39
    s_waitcnt lgkmcnt(0)
    v_mul_f32 v52, v32, v96
    v_mul_f32 v53, v32, v97
    v_mul_f32 v54, v32, v98
    v_mul_f32 v55, v32, v99
    v_fmac_f32 v52, v33, v100
    v_fmac_f32 v53, v33, v101
    v_fmac_f32 v54, v33, v102
    v_fmac_f32 v55, v33, v103
    v_fmac_f32 v52, v34, v104
    v_fmac_f32 v53, v34, v105
    v_fmac_f32 v54, v34, v106
    v_fmac_f32 v55, v34, v107
    v_fmac_f32 v52, v35, v108
    v_fmac_f32 v53, v35, v109
    v_fmac_f32 v54, v35, v110
    v_fmac_f32 v55, v35, v111
    v_fmac_f32 v52, v36, v112
    v_fmac_f32 v53, v36, v113
    v_fmac_f32 v54, v36, v114
    v_fmac_f32 v55, v36, v115
    v_fmac_f32 v52, v37, v116
    v_fmac_f32 v53, v37, v117
    v_fmac_f32 v54, v37, v118
    v_fmac_f32 v55, v37, v119
    v_fmac_f32 v52, v38, v120
    v_fmac_f32 v53, v38, v121
    v_fmac_f32 v54, v38, v122
    v_fmac_f32 v55, v38, v123
    v_fmac_f32 v52, v39, v124
    v_fmac_f32 v53, v39, v125
    v_fmac_f32 v54, v39, v126
    v_fmac_f32 v55, v39, v127
    v_perm_b32 v52, v52, v8, s53
    v_perm_b32 v53, v53, v8, s54
    v_perm_b32 v54, v54, v8, s55
    v_perm_b32 v55, v55, v8, s56
    v_mul_f32 v49, v32, v40
    v_fmac_f32 v49, v33, v41
    v_fmac_f32 v49, v34, v42
    v_fmac_f32 v49, v35, v43
    v_fmac_f32 v49, v36, v44
    v_fmac_f32 v49, v37, v45
    v_fmac_f32 v49, v38, v46
    v_fmac_f32 v49, v39, v47
    v_mov_b32 v50, v8
    v_mov_b32 v51, v8
    buffer_store_dwordx4 v[52:55], v11, s[32:35], s20 offen sc1
    v_lshrrev_b32 v10, 1, v15
    s_mov_b32 exec_lo, 0x1
    s_mov_b32 exec_hi, 0x1
    buffer_store_dwordx4 v[48:51], v10, s[32:35], s21 offen sc1
    s_mov_b64 exec, -1
    s_branch L_dutydone
L_notB:
    s_cmp_lg_u32 s40, 1
    s_cbranch_scc1 L_dutydone
    v_mov_b32 v9, 0
    s_mov_b32 s47, 400000
L_cnt56:
    ds_read_b32 v10, v9 offset:10760
    s_waitcnt lgkmcnt(0)
    v_readfirstlane_b32 s58, v10
    s_cmp_eq_u32 s58, 8
    s_cbranch_scc1 L_cnt56d
    s_sub_u32 s47, s47, 1
    s_cbranch_scc1 L_cnt56d
    s_sleep 1
    s_branch L_cnt56
L_cnt56d:
    v_lshlrev_b32 v10, 5, v0
    s_mov_b32 exec_lo, 0xff
    s_mov_b32 exec_hi, 0x0
    ds_read_b128 v[96:99], v10 offset:8192
    ds_read_b128 v[100:103], v10 offset:8208
    ds_read_b128 v[104:107], v10 offset:8448
    ds_read_b128 v[108:111], v10 offset:8464
    s_waitcnt lgkmcnt(2)
    v_max3_f32 v4, v96, v97, v98
    v_max3_f32 v5, v99, v100, v101
    v_max3_f32 v4, v4, v102, v103
    v_max_f32 v4, v4, v5
    v_sub_f32 v96, v96, v4
    v_sub_f32 v97, v97, v4
    v_sub_f32 v98, v98, v4
    v_sub_f32 v99, v99, v4
    v_sub_f32 v100, v100, v4
    v_sub_f32 v101, v101, v4
    v_sub_f32 v102, v102, v4
    v_sub_f32 v103, v103, v4
    v_exp_f32 v96, v96
    v_exp_f32 v97, v97
    v_exp_f32 v98, v98
    v_exp_f32 v99, v99
    v_exp_f32 v100, v100
    v_exp_f32 v101, v101
    v_exp_f32 v102, v102
    v_exp_f32 v103, v103
    v_mov_b32 v6, v8
    v_mov_b32 v7, v8
    ds_write_b128 v10, v[96:99] offset:9216
    ds_write_b128 v10, v[100:103] offset:9232
    s_waitcnt lgkmcnt(2)
    v_mul_f32 v5, v96, v104
    v_fmac_f32 v5, v97, v105
    v_fmac_f32 v5, v98, v106
    v_fmac_f32 v5, v99, v107
    v_fmac_f32 v5, v100, v108
    v_fmac_f32 v5, v101, v109
    v_fmac_f32 v5, v102, v110
    v_fmac_f32 v5, v103, v111
    s_mov_b64 exec, -1
L_dutydone:
    s_waitcnt vmcnt(3)
    s_cbranch_vccnz L_sk57
    s_waitcnt vmcnt(2)
L_sk57:
    buffer_load_dwordx4 v[188:191], v2, s[16:19], s44 offen offset:3072 nt
    s_add_u32 s3, s3, s96
    s_cmp_eq_u32 s3, s95
    s_cselect_b32 s3, 0, s3
    s_add_u32 s44, s45, s3
    s_waitcnt vmcnt(3)
    s_cbranch_vccnz L_sk58
    s_waitcnt vmcnt(2)
L_sk58:
    buffer_load_dwordx4 v[192:195], v2, s[16:19], s44 offen offset:0 nt
    s_cmp_eq_u32 s97, 1
    s_cbranch_scc1 L_pv0new
    v_perm_b32 v80, v132, v128, s48
    v_perm_b32 v81, v140, v136, s48
    v_perm_b32 v82, v148, v144, s48
    v_perm_b32 v83, v156, v152, s48
    v_perm_b32 v84, v132, v128, s49
    v_perm_b32 v85, v140, v136, s49
    v_perm_b32 v86, v148, v144, s49
    v_perm_b32 v87, v156, v152, s49
    v_mfma_f32_16x16x32_bf16 v[32:35], v[80:83], v[64:67], v[32:35]
    v_perm_b32 v88, v133, v129, s48
    v_perm_b32 v89, v141, v137, s48
    v_perm_b32 v90, v149, v145, s48
    v_perm_b32 v91, v157, v153, s48
    v_mfma_f32_16x16x32_bf16 v[36:39], v[84:87], v[64:67], v[36:39]
    v_perm_b32 v92, v133, v129, s49
    v_perm_b32 v93, v141, v137, s49
    v_perm_b32 v94, v149, v145, s49
    v_perm_b32 v95, v157, v153, s49
    v_mfma_f32_16x16x32_bf16 v[40:43], v[88:91], v[64:67], v[40:43]
    v_perm_b32 v80, v134, v130, s48
    v_perm_b32 v81, v142, v138, s48
    v_perm_b32 v82, v150, v146, s48
    v_perm_b32 v83, v158, v154, s48
    v_mfma_f32_16x16x32_bf16 v[44:47], v[92:95], v[64:67], v[44:47]
    v_perm_b32 v84, v134, v130, s49
    v_perm_b32 v85, v142, v138, s49
    v_perm_b32 v86, v150, v146, s49
    v_perm_b32 v87, v158, v154, s49
    v_mfma_f32_16x16x32_bf16 v[48:51], v[80:83], v[64:67], v[48:51]
    v_perm_b32 v88, v135, v131, s48
    v_perm_b32 v89, v143, v139, s48
    v_perm_b32 v90, v151, v147, s48
    v_perm_b32 v91, v159, v155, s48
    v_mfma_f32_16x16x32_bf16 v[52:55], v[84:87], v[64:67], v[52:55]
    v_perm_b32 v92, v135, v131, s49
    v_perm_b32 v93, v143, v139, s49
    v_perm_b32 v94, v151, v147, s49
    v_perm_b32 v95, v159, v155, s49
    v_mfma_f32_16x16x32_bf16 v[56:59], v[88:91], v[64:67], v[56:59]
    s_nop 1
    v_mfma_f32_16x16x32_bf16 v[60:63], v[92:95], v[64:67], v[60:63]
    s_branch L_pv0done
L_pv0new:
    v_perm_b32 v80, v132, v128, s48
    v_perm_b32 v81, v140, v136, s48
    v_perm_b32 v82, v148, v144, s48
    v_perm_b32 v83, v156, v152, s48
    v_perm_b32 v84, v132, v128, s49
    v_perm_b32 v85, v140, v136, s49
    v_perm_b32 v86, v148, v144, s49
    v_perm_b32 v87, v156, v152, s49
    v_mfma_f32_16x16x32_bf16 v[32:35], v[80:83], v[64:67], 0
    v_perm_b32 v88, v133, v129, s48
    v_perm_b32 v89, v141, v137, s48
    v_perm_b32 v90, v149, v145, s48
    v_perm_b32 v91, v157, v153, s48
    v_mfma_f32_16x16x32_bf16 v[36:39], v[84:87], v[64:67], 0
    v_perm_b32 v92, v133, v129, s49
    v_perm_b32 v93, v141, v137, s49
    v_perm_b32 v94, v149, v145, s49
    v_perm_b32 v95, v157, v153, s49
    v_mfma_f32_16x16x32_bf16 v[40:43], v[88:91], v[64:67], 0
    v_perm_b32 v80, v134, v130, s48
    v_perm_b32 v81, v142, v138, s48
    v_perm_b32 v82, v150, v146, s48
    v_perm_b32 v83, v158, v154, s48
    v_mfma_f32_16x16x32_bf16 v[44:47], v[92:95], v[64:67], 0
    v_perm_b32 v84, v134, v130, s49
    v_perm_b32 v85, v142, v138, s49
    v_perm_b32 v86, v150, v146, s49
    v_perm_b32 v87, v158, v154, s49
    v_mfma_f32_16x16x32_bf16 v[48:51], v[80:83], v[64:67], 0
    v_perm_b32 v88, v135, v131, s48
    v_perm_b32 v89, v143, v139, s48
    v_perm_b32 v90, v151, v147, s48
    v_perm_b32 v91, v159, v155, s48
    v_mfma_f32_16x16x32_bf16 v[52:55], v[84:87], v[64:67], 0
    v_perm_b32 v92, v135, v131, s49
    v_perm_b32 v93, v143, v139, s49
    v_perm_b32 v94, v151, v147, s49
    v_perm_b32 v95, v159, v155, s49
    v_mfma_f32_16x16x32_bf16 v[56:59], v[88:91], v[64:67], 0
    s_nop 1
    v_mfma_f32_16x16x32_bf16 v[60:63], v[92:95], v[64:67], 0
L_pv0done:
    v_mov_b32 v9, 0
    v_mov_b32 v10, 1
    s_mov_b32 exec_lo, 0x1
    s_mov_b32 exec_hi, 0x0
    ds_add_rtn_u32 v10, v9, v10 offset:10836
    s_waitcnt lgkmcnt(0)
    v_cmp_le_u32 vcc, 4, v10
    s_mov_b64 exec, -1
    s_waitcnt vmcnt(3)
    s_cbranch_vccnz L_sk59
    s_waitcnt vmcnt(2)
L_sk59:
    buffer_load_dwordx4 v[196:199], v2, s[16:19], s44 offen offset:1024 nt
    s_waitcnt vmcnt(3)
    s_cbranch_vccnz L_sk60
    s_waitcnt vmcnt(2)
L_sk60:
    buffer_load_dwordx4 v[200:203], v2, s[16:19], s44 offen offset:2048 nt
    s_lshl_b32 s22, s101, 4
    s_lshr_b32 s59, s43, 1
    s_add_u32 s22, s22, s59
    s_lshl_b32 s22, s22, 14
    s_lshr_b32 s58, s40, 2
    s_lshl_b32 s58, s58, 13
    s_add_u32 s22, s22, s58
    s_and_b32 s57, s40, 3
    s_lshl_b32 s57, s57, 6
    s_add_u32 s22, s22, s57
    s_add_u32 s22, s22, 1048576
    s_add_u32 s4, s22, 4096
    s_lshl_b32 s23, s101, 13
    s_lshr_b32 s57, s43, 2
    s_lshl_b32 s57, s57, 4
    s_add_u32 s23, s23, s57
    s_add_u32 s23, s23, 196608
    s_lshl_b32 s58, s42, 4
    s_add_u32 s58, s58, s59
    s_lshl_b32 s58, s58, 6
    s_lshl_b32 s24, s41, 19
    s_add_u32 s24, s24, s58
    s_and_b32 s59, s43, 1
    s_lshl_b32 s59, s59, 3
    s_add_u32 s59, s59, s40
    s_lshl_b32 s59, s59, 14
    s_add_u32 s24, s24, s59
    s_add_u32 s24, s24, 3145728
    s_xor_b32 s58, s41, 1
    s_lshl_b32 s58, s58, 9
    s_lshl_b32 s26, s40, 16
    s_add_u32 s26, s26, s58
    s_lshl_b32 s59, s42, 7
    s_add_u32 s26, s26, s59
    s_add_u32 s26, s26, 262144
    s_lshl_b32 s27, s2, 9
    s_and_b32 s59, s40, 3
    s_lshl_b32 s59, s59, 7
    s_add_u32 s27, s27, s59
    s_add_u32 s27, s27, 262144
    s_cmp_eq_u32 s41, 0
    s_cselect_b32 s12, -1, 0xf
    s_cselect_b32 s13, -1, 0xf
    s_cselect_b32 s14, -1, 0xffff
    s_cselect_b32 s15, -1, 0
    s_bfe_u32 s7, s2, 0x10001
    s_lshr_b32 s6, s2, 2
    s_xor_b32 s8, s41, 1
    s_lshl_b32 s58, s8, 1
    s_add_u32 s58, s58, s7
    s_lshl_b32 s58, s58, 6
    s_add_u32 s58, s58, s6
    s_lshl_b32 s25, s58, 12
    s_and_b32 s58, s40, 3
    s_lshl_b32 s58, s58, 10
    s_add_u32 s25, s25, s58
    s_add_u32 s25, s25, 3145728
    s_mov_b32 s10, 0
    s_mov_b32 s11, -1
    s_lshr_b32 s58, s40, 1
    s_or_b32 s9, s43, s58
    s_waitcnt vmcnt(3)
    s_cbranch_vccnz L_sk61
    s_waitcnt vmcnt(2)
L_sk61:
    buffer_load_dwordx4 v[204:207], v2, s[16:19], s44 offen offset:3072 nt
    s_add_u32 s3, s3, s96
    s_cmp_eq_u32 s3, s95
    s_cselect_b32 s3, 0, s3
    s_add_u32 s44, s45, s3
    s_waitcnt vmcnt(3)
    s_cbranch_vccnz L_sk62
    s_waitcnt vmcnt(2)
L_sk62:
    buffer_load_dwordx4 v[208:211], v2, s[16:19], s44 offen offset:0 nt
    v_perm_b32 v80, v164, v160, s48
    v_perm_b32 v81, v172, v168, s48
    v_perm_b32 v82, v180, v176, s48
    v_perm_b32 v83, v188, v184, s48
    v_perm_b32 v84, v164, v160, s49
    v_perm_b32 v85, v172, v168, s49
    v_perm_b32 v86, v180, v176, s49
    v_perm_b32 v87, v188, v184, s49
    v_mfma_f32_16x16x32_bf16 v[32:35], v[80:83], v[68:71], v[32:35]
    v_perm_b32 v88, v165, v161, s48
    v_perm_b32 v89, v173, v169, s48
    v_perm_b32 v90, v181, v177, s48
    v_perm_b32 v91, v189, v185, s48
    v_mfma_f32_16x16x32_bf16 v[36:39], v[84:87], v[68:71], v[36:39]
    v_perm_b32 v92, v165, v161, s49
    v_perm_b32 v93, v173, v169, s49
    v_perm_b32 v94, v181, v177, s49
    v_perm_b32 v95, v189, v185, s49
    v_mfma_f32_16x16x32_bf16 v[40:43], v[88:91], v[68:71], v[40:43]
    v_perm_b32 v80, v166, v162, s48
    v_perm_b32 v81, v174, v170, s48
    v_perm_b32 v82, v182, v178, s48
    v_perm_b32 v83, v190, v186, s48
    v_mfma_f32_16x16x32_bf16 v[44:47], v[92:95], v[68:71], v[44:47]
    v_perm_b32 v84, v166, v162, s49
    v_perm_b32 v85, v174, v170, s49
    v_perm_b32 v86, v182, v178, s49
    v_perm_b32 v87, v190, v186, s49
    v_mfma_f32_16x16x32_bf16 v[48:51], v[80:83], v[68:71], v[48:51]
    v_perm_b32 v88, v167, v163, s48
    v_perm_b32 v89, v175, v171, s48
    v_perm_b32 v90, v183, v179, s48
    v_perm_b32 v91, v191, v187, s48
    v_mfma_f32_16x16x32_bf16 v[52:55], v[84:87], v[68:71], v[52:55]
    v_perm_b32 v92, v167, v163, s49
    v_perm_b32 v93, v175, v171, s49
    v_perm_b32 v94, v183, v179, s49
    v_perm_b32 v95, v191, v187, s49
    v_mfma_f32_16x16x32_bf16 v[56:59], v[88:91], v[68:71], v[56:59]
    s_nop 1
    v_mfma_f32_16x16x32_bf16 v[60:63], v[92:95], v[68:71], v[60:63]
    v_mov_b32 v9, 0
    v_mov_b32 v10, 1
    s_mov_b32 exec_lo, 0x1
    s_mov_b32 exec_hi, 0x0
    ds_add_rtn_u32 v10, v9, v10 offset:10840
    s_waitcnt lgkmcnt(0)
    v_cmp_le_u32 vcc, 4, v10
    s_mov_b64 exec, -1
    s_waitcnt vmcnt(3)
    s_cbranch_vccnz L_sk63
    s_waitcnt vmcnt(2)
L_sk63:
    buffer_load_dwordx4 v[212:215], v2, s[16:19], s44 offen offset:1024 nt
    s_waitcnt vmcnt(3)
    s_cbranch_vccnz L_sk64
    s_waitcnt vmcnt(2)
L_sk64:
    buffer_load_dwordx4 v[216:219], v2, s[16:19], s44 offen offset:2048 nt
    s_waitcnt vmcnt(3)
    s_cbranch_vccnz L_sk65
    s_waitcnt vmcnt(2)
L_sk65:
    buffer_load_dwordx4 v[220:223], v2, s[16:19], s44 offen offset:3072 nt
    s_waitcnt vmcnt(3)
    s_cbranch_vccnz L_sk66
    s_waitcnt vmcnt(2)
L_sk66:
    buffer_load_dwordx4 v[96:99], v3, s[28:31], s100 offen nt
    s_add_u32 s100, s100, 16384
    v_mov_b32 v9, 0
    v_mov_b32 v10, 1
    s_mov_b32 exec_lo, 0x1
    s_mov_b32 exec_hi, 0x0
    ds_add_rtn_u32 v10, v9, v10 offset:10844
    s_waitcnt lgkmcnt(0)
    v_cmp_le_u32 vcc, 4, v10
    s_mov_b64 exec, -1
    s_waitcnt vmcnt(3)
    s_cbranch_vccnz L_sk67
    s_waitcnt vmcnt(2)
L_sk67:
    buffer_load_dwordx4 v[100:103], v3, s[28:31], s100 offen nt
    s_add_u32 s100, s100, 16384
    s_add_u32 s3, s3, s96
    s_cmp_eq_u32 s3, s95
    s_cselect_b32 s3, 0, s3
    s_add_u32 s44, s45, s3
    s_waitcnt vmcnt(3)
    s_cbranch_vccnz L_sk68
    s_waitcnt vmcnt(2)
L_sk68:
    buffer_load_dwordx4 v[224:227], v2, s[16:19], s44 offen offset:0 nt
    s_waitcnt vmcnt(3)
    v_perm_b32 v80, v196, v192, s48
    v_perm_b32 v81, v204, v200, s48
    v_perm_b32 v82, v212, v208, s48
    v_perm_b32 v83, v220, v216, s48
    v_perm_b32 v84, v196, v192, s49
    v_perm_b32 v85, v204, v200, s49
    v_perm_b32 v86, v212, v208, s49
    v_perm_b32 v87, v220, v216, s49
    v_mfma_f32_16x16x32_bf16 v[32:35], v[80:83], v[72:75], v[32:35]
    v_perm_b32 v88, v197, v193, s48
    v_perm_b32 v89, v205, v201, s48
    v_perm_b32 v90, v213, v209, s48
    v_perm_b32 v91, v221, v217, s48
    v_mfma_f32_16x16x32_bf16 v[36:39], v[84:87], v[72:75], v[36:39]
    v_perm_b32 v92, v197, v193, s49
    v_perm_b32 v93, v205, v201, s49
    v_perm_b32 v94, v213, v209, s49
    v_perm_b32 v95, v221, v217, s49
    v_mfma_f32_16x16x32_bf16 v[40:43], v[88:91], v[72:75], v[40:43]
    v_perm_b32 v80, v198, v194, s48
    v_perm_b32 v81, v206, v202, s48
    v_perm_b32 v82, v214, v210, s48
    v_perm_b32 v83, v222, v218, s48
    v_mfma_f32_16x16x32_bf16 v[44:47], v[92:95], v[72:75], v[44:47]
    v_perm_b32 v84, v198, v194, s49
    v_perm_b32 v85, v206, v202, s49
    v_perm_b32 v86, v214, v210, s49
    v_perm_b32 v87, v222, v218, s49
    v_mfma_f32_16x16x32_bf16 v[48:51], v[80:83], v[72:75], v[48:51]
    v_perm_b32 v88, v199, v195, s48
    v_perm_b32 v89, v207, v203, s48
    v_perm_b32 v90, v215, v211, s48
    v_perm_b32 v91, v223, v219, s48
    v_mfma_f32_16x16x32_bf16 v[52:55], v[84:87], v[72:75], v[52:55]
    v_perm_b32 v92, v199, v195, s49
    v_perm_b32 v93, v207, v203, s49
    v_perm_b32 v94, v215, v211, s49
    v_perm_b32 v95, v223, v219, s49
    v_mfma_f32_16x16x32_bf16 v[56:59], v[88:91], v[72:75], v[56:59]
    s_nop 1
    v_mfma_f32_16x16x32_bf16 v[60:63], v[92:95], v[72:75], v[60:63]
    s_cbranch_vccnz L_sk69
    s_waitcnt vmcnt(2)
L_sk69:
    buffer_load_dwordx4 v[228:231], v2, s[16:19], s44 offen offset:1024 nt
    v_lshrrev_b32 v9, 2, v0
    v_and_b32 v10, 3, v0
    v_lshlrev_b32 v10, 4, v10
    v_lshlrev_b32 v64, 7, v0
    v_lshl_or_b32 v65, v9, 8, v10
    s_lshr_b32 s58, s40, 2
    s_lshl_b32 s59, s58, 8
    v_lshl_add_u32 v72, v9, 3, s59
    s_lshl_b32 s58, s58, 7
    s_and_b32 s59, s40, 1
    s_lshl_b32 s59, s59, 6
    s_add_u32 s58, s58, s59
    s_and_b32 s59, s40, 2
    s_lshl_b32 s59, s59, 2
    s_add_u32 s58, s58, s59
    v_lshl_or_b32 v66, v12, 1, v10
    v_add_u32 v66, s58, v66
    v_and_b32 v10, 1, v0
    v_lshlrev_b32 v10, 4, v10
    v_bfe_u32 v67, v0, 2, 1
    v_lshlrev_b32 v67, 7, v67
    v_lshl_or_b32 v67, v12, 5, v67
    v_or_b32 v67, v67, v10
    v_bfe_u32 v9, v0, 4, 1
    v_lshlrev_b32 v9, 18, v9
    v_bfe_u32 v13, v0, 1, 2
    v_lshl_or_b32 v9, v13, 12, v9
    v_lshl_or_b32 v9, v10, 1, v9
    v_lshrrev_b32 v10, 5, v0
    v_lshl_or_b32 v68, v10, 4, v9
    v_and_b32 v9, 3, v0
    v_lshlrev_b32 v9, 6, v9
    v_lshl_or_b32 v9, v12, 4, v9
    s_and_b32 s58, s40, 3
    s_lshl_b32 s58, s58, 2
    v_add_u32 v69, s58, v9
    v_mov_b32 v70, 0
    v_and_b32 v13, 8, v0
    v_lshlrev_b32 v13, 3, v13
    v_xor_b32 v13, v13, v28
    v_lshlrev_b32 v71, 10, v0
    v_mov_b32 v16, 0xff800000
    v_mov_b32 v17, 0
    v_mov_b32 v20, 0
    v_mov_b32 v21, 0
    v_mov_b32 v22, 0
    v_mov_b32 v23, 0
    v_mov_b32 v24, 0
    v_mov_b32 v25, 0
    v_mov_b32 v26, 0
    v_mov_b32 v27, 0
    s_waitcnt vmcnt(3)
    s_cbranch_vccnz L_sk70
    s_waitcnt vmcnt(2)
L_sk70:
    buffer_load_dwordx4 v[232:235], v2, s[16:19], s44 offen offset:2048 nt
    v_mov_b32 v9, 0
    v_mov_b32 v10, 1
    s_mov_b32 exec_lo, 0x1
    s_mov_b32 exec_hi, 0x0
    ds_add_rtn_u32 v10, v9, v10 offset:10848
    s_waitcnt lgkmcnt(0)
    v_cmp_le_u32 vcc, 4, v10
    s_mov_b64 exec, -1
    s_waitcnt vmcnt(3)
    s_cbranch_vccnz L_sk71
    s_waitcnt vmcnt(2)
L_sk71:
    buffer_load_dwordx4 v[236:239], v2, s[16:19], s44 offen offset:3072 nt
    s_add_u32 s3, s3, s96
    s_cmp_eq_u32 s3, s95
    s_cselect_b32 s3, 0, s3
    s_add_u32 s44, s45, s3
    s_waitcnt vmcnt(3)
    buffer_load_dwordx4 v[240:243], v2, s[16:19], s44 offen offset:0 nt
    s_waitcnt vmcnt(3)
    buffer_load_dwordx4 v[244:247], v2, s[16:19], s44 offen offset:1024 nt
    s_waitcnt vmcnt(3)
    buffer_load_dwordx4 v[248:251], v2, s[16:19], s44 offen offset:2048 nt
    s_waitcnt vmcnt(3)
    buffer_load_dwordx4 v[252:255], v2, s[16:19], s44 offen offset:3072 nt
    s_mov_b32 s16, s15
    s_mov_b32 s17, s15
    s_waitcnt vmcnt(3)
    buffer_load_dwordx4 v[104:107], v3, s[28:31], s100 offen nt
    s_add_u32 s100, s100, 16384
    v_perm_b32 v80, v228, v224, s48
    v_perm_b32 v81, v236, v232, s48
    v_perm_b32 v84, v230, v226, s48
    v_perm_b32 v85, v238, v234, s48
    v_mfma_f32_16x16x16_bf16 v[32:35], v[80:81], v[76:77], v[32:35]
    v_perm_b32 v88, v228, v224, s49
    v_perm_b32 v89, v236, v232, s49
    v_mfma_f32_16x16x16_bf16 v[48:51], v[84:85], v[76:77], v[48:51]
    v_perm_b32 v92, v230, v226, s49
    v_perm_b32 v93, v238, v234, s49
    v_mfma_f32_16x16x16_bf16 v[36:39], v[88:89], v[76:77], v[36:39]
    v_perm_b32 v80, v229, v225, s48
    v_perm_b32 v81, v237, v233, s48
    v_mfma_f32_16x16x16_bf16 v[52:55], v[92:93], v[76:77], v[52:55]
    v_perm_b32 v84, v231, v227, s48
    v_perm_b32 v85, v239, v235, s48
    v_mfma_f32_16x16x16_bf16 v[40:43], v[80:81], v[76:77], v[40:43]
    v_perm_b32 v88, v229, v225, s49
    v_perm_b32 v89, v237, v233, s49
    v_mfma_f32_16x16x16_bf16 v[56:59], v[84:85], v[76:77], v[56:59]
    v_perm_b32 v92, v231, v227, s49
    v_perm_b32 v93, v239, v235, s49
    v_mfma_f32_16x16x16_bf16 v[44:47], v[88:89], v[76:77], v[44:47]
    s_nop 1
    v_mfma_f32_16x16x16_bf16 v[60:63], v[92:93], v[76:77], v[60:63]
    s_waitcnt vmcnt(3)
    buffer_load_dwordx4 v[108:111], v3, s[28:31], s100 offen nt
    s_add_u32 s100, s100, 16384
    s_waitcnt vmcnt(3)
    buffer_load_dwordx4 v[112:115], v3, s[28:31], s100 offen nt
    s_add_u32 s100, s100, 16384
    s_waitcnt vmcnt(3)
    buffer_load_dwordx4 v[116:119], v3, s[28:31], s100 offen nt
    s_add_u32 s100, s100, 16384
    buffer_load_dwordx4 v[120:123], v3, s[28:31], s100 offen nt
    s_add_u32 s100, s100, 16384
    buffer_load_dwordx4 v[124:127], v3, s[28:31], s100 offen nt
    v_perm_b32 v80, v244, v240, s48
    v_perm_b32 v81, v252, v248, s48
    v_perm_b32 v84, v246, v242, s48
    v_perm_b32 v85, v254, v250, s48
    v_mfma_f32_16x16x16_bf16 v[32:35], v[80:81], v[78:79], v[32:35]
    v_perm_b32 v88, v244, v240, s49
    v_perm_b32 v89, v252, v248, s49
    v_mfma_f32_16x16x16_bf16 v[48:51], v[84:85], v[78:79], v[48:51]
    v_perm_b32 v92, v246, v242, s49
    v_perm_b32 v93, v254, v250, s49
    v_mfma_f32_16x16x16_bf16 v[36:39], v[88:89], v[78:79], v[36:39]
    v_perm_b32 v80, v245, v241, s48
    v_perm_b32 v81, v253, v249, s48
    v_mfma_f32_16x16x16_bf16 v[52:55], v[92:93], v[78:79], v[52:55]
    v_perm_b32 v84, v247, v243, s48
    v_perm_b32 v85, v255, v251, s48
    v_mfma_f32_16x16x16_bf16 v[40:43], v[80:81], v[78:79], v[40:43]
    v_perm_b32 v88, v245, v241, s49
    v_perm_b32 v89, v253, v249, s49
    v_mfma_f32_16x16x16_bf16 v[56:59], v[84:85], v[78:79], v[56:59]
    v_perm_b32 v92, v247, v243, s49
    v_perm_b32 v93, v255, v251, s49
    v_mfma_f32_16x16x16_bf16 v[44:47], v[88:89], v[78:79], v[44:47]
    s_nop 1
    v_mfma_f32_16x16x16_bf16 v[60:63], v[92:93], v[78:79], v[60:63]
    s_nop 3
    v_mov_b32_dpp v32, v48 row_ror:8 row_mask:0xf bank_mask:0xc
    v_mov_b32_dpp v33, v49 row_ror:8 row_mask:0xf bank_mask:0xc
    v_mov_b32_dpp v34, v50 row_ror:8 row_mask:0xf bank_mask:0xc
    v_mov_b32_dpp v35, v51 row_ror:8 row_mask:0xf bank_mask:0xc
    ds_write_b128 v13, v[32:35] offset:12288
    v_mov_b32_dpp v36, v52 row_ror:8 row_mask:0xf bank_mask:0xc
    v_mov_b32_dpp v37, v53 row_ror:8 row_mask:0xf bank_mask:0xc
    v_mov_b32_dpp v38, v54 row_ror:8 row_mask:0xf bank_mask:0xc
    v_mov_b32_dpp v39, v55 row_ror:8 row_mask:0xf bank_mask:0xc
    v_xor_b32 v30, 16, v13
    ds_write_b128 v30, v[36:39] offset:12288
    v_mov_b32_dpp v40, v56 row_ror:8 row_mask:0xf bank_mask:0xc
    v_mov_b32_dpp v41, v57 row_ror:8 row_mask:0xf bank_mask:0xc
    v_mov_b32_dpp v42, v58 row_ror:8 row_mask:0xf bank_mask:0xc
    v_mov_b32_dpp v43, v59 row_ror:8 row_mask:0xf bank_mask:0xc
    v_xor_b32 v29, 32, v13
    ds_write_b128 v29, v[40:43] offset:12288
    v_mov_b32_dpp v44, v60 row_ror:8 row_mask:0xf bank_mask:0xc
    v_mov_b32_dpp v45, v61 row_ror:8 row_mask:0xf bank_mask:0xc
    v_mov_b32_dpp v46, v62 row_ror:8 row_mask:0xf bank_mask:0xc
    v_mov_b32_dpp v47, v63 row_ror:8 row_mask:0xf bank_mask:0xc
    v_xor_b32 v30, 48, v13
    ds_write_b128 v30, v[44:47] offset:12288
    s_cmp_lg_u32 s40, 1
    s_cbranch_scc1 L_noml
    s_mov_b32 exec_lo, 0xff
    s_mov_b32 exec_hi, 0x0
    buffer_store_dwordx4 v[4:7], v2, s[32:35], s21 offen sc1
    s_mov_b64 exec, -1
L_noml:
    s_waitcnt lgkmcnt(0)
    s_barrier
    s_cmp_ge_u32 s40, 4
    s_cbranch_scc1 L_nocomb
    ds_read_b128 v[128:131], v15 offset:9216
    ds_read_b128 v[160:163], v14 offset:12288
    ds_read_b128 v[164:167], v14 offset:16384
    ds_read_b128 v[168:171], v14 offset:20480
    ds_read_b128 v[172:175], v14 offset:24576
    ds_read_b128 v[132:135], v15 offset:9232
    ds_read_b128 v[176:179], v14 offset:28672
    ds_read_b128 v[180:183], v14 offset:32768
    ds_read_b128 v[184:187], v14 offset:36864
    ds_read_b128 v[188:191], v14 offset:40960
    s_waitcnt lgkmcnt(8)
    v_mul_f32 v148, v128, v160
    v_mul_f32 v149, v128, v161
    v_mul_f32 v150, v128, v162
    v_mul_f32 v151, v128, v163
    s_waitcnt lgkmcnt(7)
    v_fmac_f32 v148, v129, v164
    v_fmac_f32 v149, v129, v165
    v_fmac_f32 v150, v129, v166
    v_fmac_f32 v151, v129, v167
    s_waitcnt lgkmcnt(6)
    v_fmac_f32 v148, v130, v168
    v_fmac_f32 v149, v130, v169
    v_fmac_f32 v150, v130, v170
    v_fmac_f32 v151, v130, v171
    s_waitcnt lgkmcnt(5)
    v_fmac_f32 v148, v131, v172
    v_fmac_f32 v149, v131, v173
    v_fmac_f32 v150, v131, v174
    v_fmac_f32 v151, v131, v175
    s_waitcnt lgkmcnt(3)
    v_fmac_f32 v148, v132, v176
    v_fmac_f32 v149, v132, v177
    v_fmac_f32 v150, v132, v178
    v_fmac_f32 v151, v132, v179
    s_waitcnt lgkmcnt(2)
    v_fmac_f32 v148, v133, v180
    v_fmac_f32 v149, v133, v181
    v_fmac_f32 v150, v133, v182
    v_fmac_f32 v151, v133, v183
    s_waitcnt lgkmcnt(1)
    v_fmac_f32 v148, v134, v184
    v_fmac_f32 v149, v134, v185
    v_fmac_f32 v150, v134, v186
    v_fmac_f32 v151, v134, v187
    s_waitcnt lgkmcnt(0)
    v_fmac_f32 v148, v135, v188
    v_fmac_f32 v149, v135, v189
    v_fmac_f32 v150, v135, v190
    v_fmac_f32 v151, v135, v191
    v_perm_b32 v148, v148, v8, s53
    v_perm_b32 v149, v149, v8, s54
    v_perm_b32 v150, v150, v8, s55
    v_perm_b32 v151, v151, v8, s56
    buffer_store_dwordx4 v[148:151], v11, s[32:35], s20 offen sc1
    s_waitcnt vmcnt(1)
    s_branch L_wot
L_nocomb:
    s_waitcnt vmcnt(0)
L_wot:
    v_perm_b32 v192, v100, v96, s48
    v_perm_b32 v193, v108, v104, s48
    v_perm_b32 v194, v116, v112, s48
    v_perm_b32 v195, v124, v120, s48
    v_perm_b32 v208, v102, v98, s48
    v_perm_b32 v209, v110, v106, s48
    v_perm_b32 v210, v118, v114, s48
    v_perm_b32 v211, v126, v122, s48
    v_perm_b32 v196, v100, v96, s49
    v_perm_b32 v197, v108, v104, s49
    v_perm_b32 v198, v116, v112, s49
    v_perm_b32 v199, v124, v120, s49
    v_perm_b32 v212, v102, v98, s49
    v_perm_b32 v213, v110, v106, s49
    v_perm_b32 v214, v118, v114, s49
    v_perm_b32 v215, v126, v122, s49
    v_perm_b32 v200, v101, v97, s48
    v_perm_b32 v201, v109, v105, s48
    v_perm_b32 v202, v117, v113, s48
    v_perm_b32 v203, v125, v121, s48
    v_perm_b32 v216, v103, v99, s48
    v_perm_b32 v217, v111, v107, s48
    v_perm_b32 v218, v119, v115, s48
    v_perm_b32 v219, v127, v123, s48
    v_perm_b32 v204, v101, v97, s49
    v_perm_b32 v205, v109, v105, s49
    v_perm_b32 v206, v117, v113, s49
    v_perm_b32 v207, v125, v121, s49
    v_perm_b32 v220, v103, v99, s49
    v_perm_b32 v221, v111, v107, s49
    v_perm_b32 v222, v119, v115, s49
    v_perm_b32 v223, v127, v123, s49
    s_mov_b32 s47, 400000
    s_cmp_lg_u32 s40, 4
    s_cbranch_scc1 L_mldone
    s_mov_b64 exec, s[12:13]
L_mlpoll:
    buffer_load_dwordx4 v[16:19], v64, s[32:35], s23 offen sc1
L_mlchk:
    s_waitcnt vmcnt(0)
    v_cmp_ne_u32 vcc, s46, v18
    v_cmp_ne_u32 s[58:59], s46, v19
    s_or_b64 vcc, vcc, s[58:59]
    s_and_b64 exec, exec, vcc
    s_cbranch_scc0 L_mlall
    s_sub_u32 s47, s47, 1
    s_cbranch_scc1 L_mlall
    s_sleep 2
    s_branch L_mlpoll
L_mlall:
    s_mov_b64 exec, -1
    v_lshlrev_b32 v9, 3, v0
    ds_write_b64 v9, v[16:17] offset:9472
    s_waitcnt lgkmcnt(0)
L_mldone:
    s_barrier
    s_mov_b64 exec, s[14:15]
    buffer_load_dwordx4 v[20:23], v65, s[32:35], s22 offen sc1
    s_cmp_eq_u32 s41, 1
    s_cbranch_scc1 L_onea
    buffer_load_dwordx4 v[24:27], v65, s[32:35], s4 offen sc1
L_onea:
    s_mov_b64 exec, -1
    ds_read_b64 v[16:17], v72 offset:9472
    ds_read_b64 v[18:19], v72 offset:9600
    s_waitcnt lgkmcnt(0)
    v_max_f32 v28, v16, v18
    s_nop 1
    v_max_f32_dpp v28, v28, v28 row_ror:4 row_mask:0xf bank_mask:0xf
    s_nop 1
    v_max_f32_dpp v28, v28, v28 row_ror:8 row_mask:0xf bank_mask:0xf
    v_mov_b32 v29, v28
    s_nop 1
    v_permlane16_swap_b32 v28, v29
    v_max_f32 v28, v28, v29
    v_mov_b32 v29, v28
    s_nop 1
    v_permlane32_swap_b32 v28, v29
    v_max_f32 v28, v28, v29
    v_sub_f32 v16, v16, v28
    v_sub_f32 v18, v18, v28
    v_exp_f32 v16, v16
    v_exp_f32 v18, v18
    v_mul_f32 v28, v16, v17
    v_fmac_f32 v28, v18, v19
    s_nop 1
    v_add_f32_dpp v28, v28, v28 row_ror:4 row_mask:0xf bank_mask:0xf
    s_nop 1
    v_add_f32_dpp v28, v28, v28 row_ror:8 row_mask:0xf bank_mask:0xf
    v_mov_b32 v29, v28
    s_nop 1
    v_permlane16_swap_b32 v28, v29
    v_add_f32 v28, v28, v29
    v_mov_b32 v29, v28
    s_nop 1
    v_permlane32_swap_b32 v28, v29
    v_add_f32 v28, v28, v29
    v_rcp_f32 v28, v28
    s_nop 0
    v_mul_f32 v16, v16, v28
    v_mul_f32 v18, v18, v28
    s_mov_b32 s47, 400000
    s_mov_b64 exec, s[14:15]
    s_waitcnt vmcnt(0)
L_opoll:
    v_perm_b32 v28, v21, v20, s50
    v_perm_b32 v29, v23, v22, s51
    v_or_b32 v28, v28, v29
    v_cmp_ne_u32 vcc, s46, v28
    v_perm_b32 v30, v25, v24, s50
    v_perm_b32 v31, v27, v26, s51
    v_or_b32 v30, v30, v31
    v_cmp_ne_u32 s[58:59], s46, v30
    s_and_b64 s[58:59], s[58:59], s[16:17]
    s_or_b64 vcc, vcc, s[58:59]
    s_cbranch_scc0 L_odone
    s_sub_u32 s47, s47, 1
    s_cbranch_scc1 L_odone
    s_sleep 1
    buffer_load_dwordx4 v[20:23], v65, s[32:35], s22 offen sc1
    s_cmp_eq_u32 s41, 1
    s_cbranch_scc1 L_oneb
    buffer_load_dwordx4 v[24:27], v65, s[32:35], s4 offen sc1
L_oneb:
    s_waitcnt vmcnt(0)
    s_branch L_opoll
L_odone:
    s_mov_b64 exec, -1
    v_mul_f32 v20, v16, v20
    v_mul_f32 v21, v16, v21
    v_mul_f32 v22, v16, v22
    v_mul_f32 v23, v16, v23
    v_fmac_f32 v20, v18, v24
    v_fmac_f32 v21, v18, v25
    v_fmac_f32 v22, v18, v26
    v_fmac_f32 v23, v18, v27
    v_permlane16_swap_b32 v20, v21
    s_nop 0
    v_permlane16_swap_b32 v22, v23
    v_add_f32 v20, v20, v21
    v_add_f32 v22, v22, v23
    s_nop 1
    v_permlane32_swap_b32 v20, v22
    v_add_f32 v20, v20, v22
    s_nop 1
    v_add_f32_dpp v20, v20, v20 row_ror:8 row_mask:0xf bank_mask:0xf
    s_nop 1
    v_add_f32_dpp v20, v20, v20 row_ror:4 row_mask:0xf bank_mask:0xf
    v_cvt_pk_bf16_f32 v20, v20, v20
    s_mov_b32 exec_lo, 0xf000f
    s_mov_b32 exec_hi, 0xf000f
    ds_write_b16 v66, v20 offset:9984
    s_mov_b64 exec, -1
    s_waitcnt lgkmcnt(0)
    s_barrier
    ds_read_b128 v[28:31], v67 offset:9984
    s_cmp_lg_u32 s9, 0
    s_cbranch_scc1 L_nof2
    buffer_store_dword v8, v71, s[32:35], s26 offen sc1
L_nof2:
    s_waitcnt lgkmcnt(0)
    v_mfma_f32_16x16x32_bf16 v[32:35], v[28:31], v[192:195], 0
    v_mfma_f32_16x16x32_bf16 v[48:51], v[28:31], v[208:211], 0
    v_mfma_f32_16x16x32_bf16 v[36:39], v[28:31], v[196:199], 0
    v_mfma_f32_16x16x32_bf16 v[52:55], v[28:31], v[212:215], 0
    v_mfma_f32_16x16x32_bf16 v[40:43], v[28:31], v[200:203], 0
    v_mfma_f32_16x16x32_bf16 v[56:59], v[28:31], v[216:219], 0
    v_mfma_f32_16x16x32_bf16 v[44:47], v[28:31], v[204:207], 0
    v_mfma_f32_16x16x32_bf16 v[60:63], v[28:31], v[220:223], 0
    s_nop 1
    v_cndmask_b32 v24, v33, v49, s[10:11]
    v_cndmask_b32 v16, v32, v48, s[10:11]
    v_cndmask_b32 v25, v37, v53, s[10:11]
    v_cndmask_b32 v17, v36, v52, s[10:11]
    v_cndmask_b32 v26, v41, v57, s[10:11]
    v_cndmask_b32 v18, v40, v56, s[10:11]
    v_cndmask_b32 v27, v45, v61, s[10:11]
    v_cndmask_b32 v19, v44, v60, s[10:11]
    v_add_f32_dpp v16, v24, v16 row_ror:8 row_mask:0xf bank_mask:0xf
    v_add_f32_dpp v17, v25, v17 row_ror:8 row_mask:0xf bank_mask:0xf
    v_add_f32_dpp v18, v26, v18 row_ror:8 row_mask:0xf bank_mask:0xf
    v_add_f32_dpp v19, v27, v19 row_ror:8 row_mask:0xf bank_mask:0xf
    v_perm_b32 v16, v16, v8, s53
    v_perm_b32 v17, v17, v8, s54
    v_perm_b32 v18, v18, v8, s55
    v_perm_b32 v19, v19, v8, s56
    s_mov_b32 exec_lo, 0xff00ff
    s_mov_b32 exec_hi, 0xff00ff
    buffer_store_dwordx4 v[16:19], v68, s[32:35], s24 offen sc1
    s_mov_b64 exec, -1
    s_cmp_ge_u32 s40, 4
    s_cbranch_scc1 L_fin
    s_mov_b32 s47, 400000
L_f2poll:
    s_load_dword s58, s[32:33], s27 glc
    s_waitcnt lgkmcnt(0)
    s_cmp_eq_u32 s58, s46
    s_cbranch_scc1 L_f2done
    s_sub_u32 s47, s47, 1
    s_cbranch_scc1 L_f2done
    s_sleep 1
    s_branch L_f2poll
L_f2done:
    s_mov_b32 s47, 400000
L_fpoll:
    buffer_load_dwordx4 v[20:23], v2, s[32:35], s25 offen sc1
    s_waitcnt vmcnt(0)
    v_perm_b32 v25, v21, v20, s50
    v_perm_b32 v26, v23, v22, s51
    v_or_b32 v25, v25, v26
    v_cmp_ne_u32 vcc, s46, v25
    s_cmp_eq_u64 vcc, 0
    s_cbranch_scc1 L_fdone
    s_sub_u32 s47, s47, 1
    s_cbranch_scc1 L_fdone
    s_sleep 1
    s_branch L_fpoll
L_fdone:
    v_permlane16_swap_b32 v20, v21
    v_permlane16_swap_b32 v22, v23
    v_add_f32 v20, v20, v21
    v_add_f32 v22, v22, v23
    s_nop 1
    v_permlane32_swap_b32 v20, v22
    v_add_f32 v20, v20, v22
    s_nop 1
    v_add_f32_dpp v20, v20, v20 row_ror:8 row_mask:0xf bank_mask:0xf
    s_nop 1
    v_add_f32_dpp v20, v20, v20 row_ror:4 row_mask:0xf bank_mask:0xf
    s_mov_b32 exec_lo, 0xf000f
    s_mov_b32 exec_hi, 0xf000f
    ds_write_b32 v69, v20 offset:10240
    s_mov_b64 exec, -1
    s_lshl_b32 s44, s7, 12
    s_lshl_b32 s58, s8, 11
    s_add_u32 s44, s44, s58
    s_lshl_b32 s58, s6, 5
    s_add_u32 s44, s44, s58
    v_lshlrev_b32 v9, 1, v0
    s_waitcnt lgkmcnt(0)
    s_barrier
    s_cmp_lg_u32 s40, 0
    s_cbranch_scc1 L_fin
    s_mov_b32 exec_lo, 0xffff
    s_mov_b32 exec_hi, 0x0
    ds_read_b128 v[16:19], v2 offset:10240
    s_waitcnt lgkmcnt(0)
    v_add_f32 v16, v16, v17
    v_add_f32 v18, v18, v19
    v_add_f32 v16, v16, v18
    v_cvt_pk_bf16_f32 v16, v16, v16
    buffer_store_short v16, v9, s[36:39], s44 offen
    s_cmp_lg_u32 s2, 0
    s_cbranch_scc1 L_fin
    s_mov_b32 exec_lo, 0x1
    s_mov_b32 exec_hi, 0x0
    buffer_store_dword v8, v70, s[32:35], 0 offen
L_fin:
L_end:
    s_endpgm
.section .rodata,"a"
.p2align 6
.amdhsa_kernel concat_heads__gqa_block_cached__sliding_block_cached__decode_kernel
.amdhsa_next_free_vgpr 256
.amdhsa_next_free_sgpr 102
.amdhsa_accum_offset 256
.amdhsa_group_segment_fixed_size 0
.amdhsa_kernarg_size 104
.amdhsa_user_sgpr_count 2
.amdhsa_user_sgpr_kernarg_segment_ptr 1
.amdhsa_system_sgpr_workgroup_id_x 1
.amdhsa_float_denorm_mode_32 3
.end_amdhsa_kernel
```
